```python
import torch

def _softmax(x, axis=-1):
    return torch.softmax(x, dim=axis)
def _gelu(x):
    return torch.nn.functional.gelu(x, approximate="tanh")
def _silu(x):
    return torch.nn.functional.silu(x)
def _sigmoid(x):
    return torch.sigmoid(x)
def _layernorm(x, axis=-1, eps=1e-5):
    m = x.mean(dim=axis, keepdim=True)
    v = x.var(dim=axis, keepdim=True, unbiased=False)
    return (x - m) / torch.sqrt(v + eps)
def _scatter_add(tgt, idx, src, axis=0):
    return tgt.clone().index_add_(axis, idx, src)
def _segment_sum(src, seg, n):
    out = torch.zeros((n,) + src.shape[1:], dtype=src.dtype)
    return out.index_add_(0, seg, src)
def _pad(x, pw):
    flat = tuple(v for pair in reversed(pw) for v in pair)
    return torch.nn.functional.pad(x, flat)

kernel_name = 'gated_mix__ssm_conv_s4d__spectral_gfnet__prompt'

def setup_inputs():

    _w = (lambda a: (lambda t: t.to(torch.bfloat16) if t.is_floating_point() else t)(torch.as_tensor(a)))
    def _A_setup():
        Bsz, L, D, N = 1, 2048, 512, 128
        return {
            "u": _w((lambda *s: torch.randn(*s, dtype=torch.bfloat16) * 0.05)(Bsz, L, D)),
            "log_A_real": _w((lambda *s: torch.randn(*s, dtype=torch.bfloat16) * 3.2)(D, N) * 0.5),
            "A_imag": _w((lambda *s: torch.randn(*s, dtype=torch.bfloat16) * 0.05)(D, N) * 3.14),
            "C_real": _w((lambda *s: torch.randn(*s, dtype=torch.bfloat16) * 0.1)(D, N) / N ** 0.5),
            "C_imag": _w((lambda *s: torch.randn(*s, dtype=torch.bfloat16) * 0.1)(D, N) / N ** 0.5),
            "log_dt": _w((lambda *s: torch.randn(*s, dtype=torch.bfloat16) * 0.05)(D) * 0.5 - 4.0),
            "D_skip": _w((lambda *s: torch.randn(*s, dtype=torch.bfloat16) * 0.05)(D)),
        }
    _A_in = _A_setup()

    def _B_setup():
        B, S, D = 1, 2048, 512
        Df = D // 2 + 1
        return {
            "x": _w((lambda *s: torch.randn(*s, dtype=torch.bfloat16) * 0.05)(B, S, D)),
            "w_r": _w((lambda *s: torch.randn(*s, dtype=torch.bfloat16) * 1.6)(S, Df) * 0.02),
            "w_i": _w((lambda *s: torch.randn(*s, dtype=torch.bfloat16) * 1.6)(S, Df) * 0.02),
        }
    _B_in = _B_setup()

    return {
        "A_u": _A_in["u"],
        "A_log_A_real": _A_in["log_A_real"],
        "A_A_imag": _A_in["A_imag"],
        "A_C_real": _A_in["C_real"],
        "A_C_imag": _A_in["C_imag"],
        "A_log_dt": _A_in["log_dt"],
        "A_D_skip": _A_in["D_skip"],
        "B_x": _B_in["x"],
        "B_w_r": _B_in["w_r"],
        "B_w_i": _B_in["w_i"],
        "gate_w": _w((lambda *s: torch.randn(*s, dtype=torch.bfloat16) * 0.05)(512) * 16.0),
    }

def reference(A_u, A_log_A_real, A_A_imag, A_C_real, A_C_imag, A_log_dt, A_D_skip, B_x, B_w_r, B_w_i, gate_w):
    def _A_ref(u, log_A_real, A_imag, C_real, C_imag, log_dt, D_skip):
        L = u.shape[1]
        dt = torch.exp(log_dt)
        A = -torch.exp(log_A_real) + 1j * A_imag
        C = (C_real + 1j * C_imag) * dt[:, None]
        pos = (lambda x, dt: x.to(dt))(torch.arange(L), log_dt.dtype)
        P = torch.exp((A * dt[:, None])[:, :, None] * pos[None, None, :])
        K = 2.0 * torch.einsum("dn,dnl->dl", C, P).real
        L2 = 2 * L
        u_t = (lambda x, *d: x.permute(*d))(u, 0, 2, 1)
        Kf = (lambda x, *a, **k: torch.fft.rfft(x.float(), *a, **k))(K, L2)
        Uf = (lambda x, *a, **k: torch.fft.rfft(x.float(), *a, **k))(u_t, L2)
        y = (lambda x, *a, **k: torch.fft.irfft(x, *a, **k).to(torch.bfloat16))(Uf * Kf[None, :, :], L2)[:, :, :L]
        y = (lambda x, *d: x.permute(*d))(y, 0, 2, 1)
        return y + u * D_skip[None, None, :]

    def _B_ref(x, w_r, w_i):
        B, S, D = x.shape
        X = (lambda x, axes=(-2,-1): torch.fft.rfft2(x.float(), dim=axes))(x, axes=(-2, -1))
        W = w_r + 1j * w_i
        X = X * W
        y = (lambda x, s, axes=(-2,-1): torch.fft.irfft2(x, s=s, dim=axes).to(torch.bfloat16))(X, (S, D), axes=(-2, -1))
        return y

    x = A_u
    g = _sigmoid((x * gate_w).sum(-1, keepdims=True))
    a = _A_ref(x, A_log_A_real, A_A_imag, A_C_real, A_C_imag, A_log_dt, A_D_skip)
    b = _B_ref(x, B_w_r, B_w_i)
    return g * a + (1 - g) * b
```

```asm
; @launch grid=(512,1,1) block=(256,1,1) lds=72832
.amdgcn_target "amdgcn-amd-amdhsa--gfx950"
.text
.globl gated_mix__ssm_conv_s4d__spectral_gfnet__prompt_kernel
.p2align 8
.type gated_mix__ssm_conv_s4d__spectral_gfnet__prompt_kernel,@function
gated_mix__ssm_conv_s4d__spectral_gfnet__prompt_kernel:
    s_load_dwordx16 s[4:19], s[0:1], 0
    s_load_dwordx2 s[20:21], s[0:1], 104
    s_load_dwordx8 s[48:55], s[0:1], 64
    s_cmp_ge_u32 s2, 8
    s_cbranch_scc1 L_nopf
    s_getpc_b64 s[62:63]
L_pc:
    v_lshlrev_b32 v1, 7, v0
    v_cmp_gt_u32 vcc, L_code_end-L_pc, v1
    s_nop 0
    s_and_saveexec_b64 s[58:59], vcc
    s_cbranch_execz L_pf2
    global_load_dword v255, v1, s[62:63]
L_pf2:
    s_mov_b64 exec, -1
L_nopf:
    s_cmp_ge_u32 s2, 512
    s_cbranch_scc1 L_exit
    s_cmp_lt_u32 s2, 256
    s_cbranch_scc1 L_a_pre
L_b_pre:
    s_setprio 2
    s_and_b32 s22, s2, 7
    s_lshl_b32 s22, s22, 5
    s_bfe_u32 s23, s2, 0x50003
    s_or_b32 s22, s22, s23
    v_lshrrev_b32 v2, 6, v0
    v_and_b32 v1, 15, v0
    v_readfirstlane_b32 s3, v2
    v_bfe_u32 v2, v0, 4, 2
    v_and_b32 v5, 63, v0
    v_lshlrev_b32 v5, 4, v5
    s_lshl_b32 s24, s3, 9
    s_add_u32 s24, s24, s22
    s_lshl_b32 s24, s24, 10
    s_add_u32 s25, s24, 262144
    s_mul_i32 s26, s3, 2112
    s_mov_b32 s30, 2097152
    s_mov_b32 s31, 0x00020000
    v_lshrrev_b32 v60, 3, v1
    s_lshl_b32 s56, s3, 1
    v_and_b32 v3, 1, v2
    v_add_u32 v60, s56, v60
    v_lshlrev_b32 v3, 2, v3
    v_and_b32 v61, 7, v1
    v_mul_u32_u24 v3, v3, v60
    v_and_b32 v4, 2, v2
    v_mad_u32_u24 v3, v4, v61, v3
    v_cvt_f32_u32 v9, v3
    v_cvt_f32_u32 v62, v60
    v_mul_f32 v9, 0.125, v9
    v_fmamk_f32 v101, v62, 0x3e000000, v9
    v_fmamk_f32 v102, v62, 0x3e800000, v9
    v_fmamk_f32 v103, v62, 0x3ec00000, v9
    v_cos_f32 v92, v9
    v_sin_f32 v96, v9
    v_cos_f32 v93, v101
    v_sin_f32 v97, v101
    v_cos_f32 v94, v102
    v_sin_f32 v98, v102
    v_cos_f32 v95, v103
    v_sin_f32 v99, v103
    v_cvt_f32_u32 v63, v61
    v_fmamk_f32 v9, v63, 0x3e000000, v9
    v_cvt_pk_bf16_f32 v112, v92, v93
    v_cvt_pk_bf16_f32 v113, v94, v95
    v_cvt_pk_bf16_f32 v120, -v96, -v97
    v_cvt_pk_bf16_f32 v121, -v98, -v99
    v_fmamk_f32 v101, v62, 0x3e000000, v9
    v_fmamk_f32 v102, v62, 0x3e800000, v9
    v_fmamk_f32 v103, v62, 0x3ec00000, v9
    v_cos_f32 v92, v9
    v_sin_f32 v96, v9
    v_cos_f32 v93, v101
    v_sin_f32 v97, v101
    v_cos_f32 v94, v102
    v_sin_f32 v98, v102
    v_cos_f32 v95, v103
    v_sin_f32 v99, v103
    v_and_b32 v64, 1, v61
    v_mul_u32_u24 v64, 0x8000, v64
    v_lshl_or_b32 v64, v64, 16, v64
    v_cvt_pk_bf16_f32 v114, v92, v93
    v_cvt_pk_bf16_f32 v115, v94, v95
    v_cvt_pk_bf16_f32 v122, -v96, -v97
    v_cvt_pk_bf16_f32 v123, -v98, -v99
    v_xor_b32 v116, v64, v112
    v_xor_b32 v124, v64, v120
    v_xor_b32 v117, v64, v113
    v_xor_b32 v125, v64, v121
    v_xor_b32 v118, v64, v114
    v_xor_b32 v126, v64, v122
    v_xor_b32 v119, v64, v115
    v_xor_b32 v127, v64, v123
    s_waitcnt lgkmcnt(0)
    s_mov_b32 s28, s4
    s_mov_b32 s29, s5
    s_mov_b32 m0, s26
    s_nop 0
    buffer_load_dwordx4 v5, s[28:31], s24 offen lds
    s_add_u32 m0, s26, 1056
    s_nop 0
    buffer_load_dwordx4 v5, s[28:31], s25 offen lds
    s_bitcmp1_b32 s3, 0
    s_cselect_b32 s40, s16, s52
    s_cselect_b32 s41, s17, s53
    s_mov_b32 s42, 1024
    s_mov_b32 s43, 0x00020000
    s_cselect_b32 s56, 1024, 0
    s_add_u32 m0, s56, 53824
    s_nop 0
    buffer_load_dwordx4 v5, s[40:43], 0 offen lds
    s_mov_b32 s44, s20
    s_mov_b32 s45, s21
    s_mov_b32 s46, 16777216
    s_mov_b32 s47, 0x00020000
    s_add_u32 s20, s20, 12845056
    s_addc_u32 s21, s21, 0
    s_load_dword s57, s[20:21], 0
    s_mov_b32 s32, s48
    s_mov_b32 s33, s49
    s_mov_b32 s34, 1052672
    s_mov_b32 s35, 0x00020000
    s_mov_b32 s36, s50
    s_mov_b32 s37, s51
    s_mov_b32 s38, 1052672
    s_mov_b32 s39, 0x00020000
    s_mov_b32 s12, s54
    s_mov_b32 s13, s55
    s_mov_b32 s14, 2097152
    s_mov_b32 s15, 0x00020000
    s_and_b32 s27, s2, 7
    s_mul_i32 s61, s27, 514
    s_lshl_b32 s62, s23, 4
    s_add_u32 s62, s62, s61
    s_mul_i32 s6, s22, 8448
    s_lshl_b32 s7, s3, 11
    s_add_u32 s6, s6, s7
    s_mul_i32 s7, s3, 3072
    s_add_u32 s8, s6, 2162688
    s_mul_i32 s63, s23, 32896
    s_add_u32 s63, s63, s61
    s_and_b32 s63, s63, -4
    s_branch L_b2
L_a_pre:
    s_setprio 2
    s_and_b32 s22, s2, 7
    s_lshl_b32 s22, s22, 5
    s_bfe_u32 s23, s2, 0x50003
    s_or_b32 s22, s22, s23
    v_lshrrev_b32 v2, 6, v0
    v_and_b32 v1, 15, v0
    v_readfirstlane_b32 s3, v2
    v_bfe_u32 v2, v0, 4, 2
    v_lshlrev_b32 v128, 1, v0
    v_lshrrev_b32 v5, 7, v0
    v_lshlrev_b32 v129, 1, v5
    v_and_b32 v4, 0xc0, v0
    v_lshl_add_u32 v4, v1, 2, v4
    v_lshl_add_u32 v130, v2, 13, v4
    s_lshl_b32 s24, s22, 9
    s_lshl_b32 s25, s22, 2
    s_lshr_b32 s26, s23, 2
    s_lshl_b32 s26, s26, 3
    s_and_b32 s27, s2, 7
    s_add_u32 s26, s26, s27
    s_and_b32 s27, s23, 3
    s_lshl_b32 s28, s26, 15
    s_lshl_b32 s29, s27, 8
    s_add_u32 s28, s28, s29
    s_add_u32 s29, s28, 4096
    s_mov_b32 s34, 131072
    s_mov_b32 s35, 0x00020000
    s_mov_b32 s38, 131072
    s_mov_b32 s39, 0x00020000
    s_mov_b32 s42, 1024
    s_mov_b32 s43, 0x00020000
    s_mov_b32 s46, 2097152
    s_mov_b32 s47, 0x00020000
    s_waitcnt lgkmcnt(0)
    s_mov_b32 s40, s14
    s_mov_b32 s41, s15
    buffer_load_short_d16_hi v10, v129, s[40:43], s25 offen
    s_mov_b32 s32, s6
    s_mov_b32 s33, s7
    buffer_load_short_d16_hi v6, v128, s[32:35], s24 offen
    s_mov_b32 s36, s8
    s_mov_b32 s37, s9
    buffer_load_short_d16_hi v7, v128, s[36:39], s24 offen
    s_mov_b32 s32, s10
    s_mov_b32 s33, s11
    buffer_load_short_d16_hi v8, v128, s[32:35], s24 offen
    s_mov_b32 s36, s12
    s_mov_b32 s37, s13
    buffer_load_short_d16_hi v9, v128, s[36:39], s24 offen
    s_mov_b32 s44, s4
    s_mov_b32 s45, s5
    buffer_load_dword v132, v130, s[44:47], s28 offen offset:0
    buffer_load_dword v133, v130, s[44:47], s28 offen offset:1024
    buffer_load_dword v134, v130, s[44:47], s28 offen offset:2048
    buffer_load_dword v135, v130, s[44:47], s28 offen offset:3072
    buffer_load_dword v136, v130, s[44:47], s29 offen offset:0
    buffer_load_dword v137, v130, s[44:47], s29 offen offset:1024
    buffer_load_dword v138, v130, s[44:47], s29 offen offset:2048
    buffer_load_dword v139, v130, s[44:47], s29 offen offset:3072
    s_mov_b32 s48, s20
    s_mov_b32 s49, s21
    s_mov_b32 s50, 16777216
    s_mov_b32 s51, 0x00020000
    s_add_u32 s20, s20, 12845056
    s_addc_u32 s21, s21, 0
    s_load_dword s4, s[20:21], 0
    s_mul_i32 s27, s27, 540672
    s_lshl_b32 s26, s26, 7
    s_add_u32 s26, s26, s27
    s_add_u32 s26, s26, 6488064
    s_add_u32 s27, s26, 4096
    s_add_u32 s28, s26, 8192
    s_mov_b32 s8, 0x05040100
    s_mov_b32 s9, 0x07060302
    s_and_b32 s6, s3, 1
    s_lshr_b32 s7, s3, 1
    s_mul_i32 s10, s7, 28832
    s_lshl_b32 s11, s6, 8
    s_add_u32 m0, s10, s11
    s_mul_i32 s52, s22, 8448
    s_add_u32 s52, s52, 6488064
    s_add_u32 s53, s52, 4096
    s_mul_i32 s10, s6, 28832
    s_mul_i32 s11, s7, 8704
    s_add_u32 s11, s11, 11424
    s_mul_i32 s12, s6, 2432
    s_mul_i32 s13, s7, 288
    s_add_u32 s12, s12, s13
    s_add_u32 s12, s12, 57728
    s_mov_b32 s14, 0x90480100
    s_mov_b32 s15, 0x08040202
    s_mov_b32 s16, 0x90020101
    v_and_b32 v237, 127, v0
    v_lshlrev_b32 v47, 4, v1
    v_lshrrev_b32 v238, 1, v1
    s_lshl_b32 s19, s6, 9
    v_lshlrev_b32 v232, 3, v237
    v_lshl_add_u32 v47, v238, 2, v47
    v_lshlrev_b32 v3, 3, v2
    s_add_u32 s19, s19, 62592
    v_sub_u32 v232, 1016, v232
    v_add_u32 v47, s12, v47
    v_bfe_u32 v43, s14, v3, 8
    s_lshl_b32 s13, s7, 5
    v_or_b32 v233, 1, v232
    v_lshl_add_u32 v43, v43, 3, v47
    s_add_u32 s13, s13, s19
    v_add_u32 v240, 2304, v47
    v_ffbh_u32 v233, v233
    s_add_u32 s13, s13, 126
    v_lshlrev_b32 v47, 1, v1
    v_cmp_eq_u32 vcc, 0, v2
    v_sub_u32 v233, 24, v233
    v_add_u32 v47, s13, v47
    v_mov_b32 v239, 64128
    v_mul_u32_u24 v38, 4480, v5
    v_max_i32 v233, 0, v233
    v_cndmask_b32 v48, v239, v47, vcc
    v_lshl_add_u32 v38, v237, 4, v38
    v_add_u32 v234, 150, v233
    v_cmp_eq_u32 vcc, 1, v2
    v_lshlrev_b32 v234, 23, v234
    v_lshrrev_b32 v237, v233, v232
    v_add_u32 v239, 256, v47
    v_mul_u32_u24 v236, 2432, v5
    v_add_u32 v234, v234, v237
    v_cndmask_b32 v47, v48, v239, vcc
    v_add_u32 v236, 57728, v236
    v_lshrrev_b32 v237, 4, v232
    v_and_b32 v239, 0xbf, v0
    v_add_u32 v233, 1, v233
    v_lshl_add_u32 v237, v237, 2, v236
    v_cmp_eq_u32 vcc, 0, v239
    v_lshlrev_b32 v235, v233, v234
    v_lshl_add_u32 v29, v232, 1, v237
    v_sub_u32 v235, v29, v235
    v_add_f32 v35, 0x40c00000, v234
    v_cndmask_b32 v47, v47, v240, vcc
    v_add_u32 v237, 16, v29
    v_lshl_add_u32 v35, v35, v233, v235
    v_bfe_u32 v240, v232, 3, 1
    v_cmp_eq_u32 vcc, v35, v237
    v_lshlrev_b32 v240, 2, v240
    v_add_f32 v36, 0x40e00000, v234
    v_cndmask_b32 v28, 0, v240, vcc
    v_lshl_add_u32 v36, v36, v233, v235
    v_cmp_eq_u32 vcc, v36, v237
    v_add_u32 v35, v35, v28
    v_bfe_u32 v45, s16, v3, 8
    v_cndmask_b32 v28, 0, v240, vcc
    v_cmp_ge_u32 vcc, 256, v232
    v_sub_u32 v240, 6, v240
    v_add_u32 v36, v36, v28
    v_cndmask_b32 v237, 0, v240, vcc
    v_sub_u32 v28, v29, v237
    v_bfe_u32 v238, s15, v3, 8
    v_lshl_add_u32 v45, v45, 2, v43
    v_and_b32 v237, 16, v0
    v_add_u32 v44, v43, v238
    v_add_u32 v46, v45, v238
    v_bfe_u32 v241, v0, 6, 1
    v_cmp_ne_u32 vcc, 0, v237
    v_lshl_add_u32 v241, v1, 1, v241
    v_and_b32 v238, 16, v0
    v_cndmask_b32 v241, v241, 0, vcc
    v_mul_u32_u24 v238, 132, v238
    v_lshlrev_b32 v12, 4, v0
    v_cmp_le_u32 vcc, 26, v241
    v_lshl_add_u32 v53, v1, 2, v238
    v_lshrrev_b32 v54, 3, v0
    v_and_b32 v151, 31, v0
    v_mov_b32 v40, 0x10000
    v_lshlrev_b32 v54, 6, v54
    v_and_b32 v238, 48, v12
    v_mul_u32_u24 v144, 2432, v5
    v_mov_b32 v37, 0
    v_lshlrev_b32 v151, 2, v151
    v_mul_u32_u24 v146, 4096, v5
    v_cndmask_b32 v40, 0, v40, vcc
    v_add_u32 v54, v54, v238
    ds_write_b32 v144, v37 offset:57720
    v_lshl_add_u32 v151, v5, 9, v151
    v_lshl_add_u32 v146, v0, 2, v146
    v_mul_u32_u24 v41, 544, v1
    v_cmp_le_u32 vcc, 27, v241
    v_bfe_u32 v238, v0, 2, 1
    ds_write_b32 v151, v37 offset:62592
    v_add_u32 v146, 63616, v146
    v_lshl_add_u32 v41, v2, 4, v41
    v_mul_u32_u24 v238, 4608, v238
    v_mul_u32_u24 v131, 2112, v4
    ds_write_b32 v146, v37
    v_mov_b32 v147, 0x3f80
    v_add_u32 v41, s10, v41
    v_add_f32 v30, 0x3f800000, v234
    v_add_f32 v31, 0x40000000, v234
    v_add_f32 v32, 0x40400000, v234
    v_add_f32 v33, 0x40800000, v234
    v_add_f32 v34, 0x40a00000, v234
    v_cndmask_b32 v241, 0, 1, vcc
    s_mul_i32 s18, s3, 2240
    v_add_u32 v54, v54, v238
    v_lshl_add_u32 v131, v2, 4, v131
    ds_write_addtid_b32 v147 offset:11424
    v_add_u32 v42, s11, v41
    v_lshl_add_u32 v30, v30, v233, v235
    v_lshl_add_u32 v31, v31, v233, v235
    v_lshl_add_u32 v32, v32, v233, v235
    v_lshl_add_u32 v33, v33, v233, v235
    v_lshl_add_u32 v34, v34, v233, v235
    v_add_u32 v39, 2304, v236
    v_or_b32 v40, v40, v241
    v_add_u32 v53, s18, v53
    v_add_u32 v54, 64128, v54
    s_waitcnt vmcnt(12)
    v_mul_f32 v152, 0x3fb8aa3b, v10
    s_waitcnt vmcnt(11)
    v_mul_f32 v153, 0x3fb8aa3b, v6
    v_exp_f32 v152, v152
    v_exp_f32 v153, v153
    s_nop 0
    v_cvt_pk_bf16_f32 v3, v152, v153
    v_lshlrev_b32 v152, 16, v3
    v_and_b32 v153, 0xffff0000, v3
    s_waitcnt vmcnt(10)
    v_mul_f32 v154, v7, v152
    v_mul_f32 v153, v153, v152
    v_mul_f32 v154, 0.15915494, v154
    v_mul_f32 v153, 0xbfb8aa3b, v153
    v_mul_f32 v160, 0x41000000, v154
    v_mul_f32 v161, 0x3f800000, v154
    v_mul_f32 v162, 0x43000000, v154
    v_mul_f32 v163, 0x43800000, v154
    v_mul_f32 v156, 0x41000000, v153
    v_fract_f32 v160, v160
    v_mul_f32 v157, 0x3f800000, v153
    v_fract_f32 v161, v161
    v_mul_f32 v158, 0x43000000, v153
    v_fract_f32 v162, v162
    v_mul_f32 v159, 0x43800000, v153
    v_fract_f32 v163, v163
    v_exp_f32 v156, v156
    v_cos_f32 v164, v160
    v_sin_f32 v165, v160
    v_exp_f32 v157, v157
    v_cos_f32 v166, v161
    v_sin_f32 v167, v161
    v_exp_f32 v158, v158
    v_cos_f32 v168, v162
    v_sin_f32 v169, v162
    v_exp_f32 v159, v159
    v_cos_f32 v170, v163
    v_sin_f32 v171, v163
    v_mul_f32 v152, 0x4000b7c2, v152
    s_waitcnt vmcnt(9)
    v_mul_f32 v172, v8, v152
    s_waitcnt vmcnt(8)
    v_mul_f32 v173, v9, v152
    v_mul_f32 v164, v156, v164
    v_mul_f32 v165, v156, v165
    v_mul_f32 v166, v157, v166
    v_mul_f32 v167, v157, v167
    v_mul_f32 v168, v158, v168
    v_mul_f32 v169, v158, v169
    v_mul_f32 v170, v159, v170
    v_mul_f32 v171, v159, v171
    s_waitcnt lgkmcnt(0)
    s_xor_b32 s4, s4, 0xffff
    s_add_u32 s4, s4, 0x9e370000
    v_lshlrev_b32 v146, 2, v2
    v_lshrrev_b32 v24, v146, s4
    s_mov_b32 s5, 0x10001
    v_lshrrev_b32 v25, 1, v24
    v_lshrrev_b32 v26, 2, v24
    v_lshrrev_b32 v27, 3, v24
    s_waitcnt vmcnt(6)
    v_perm_b32 v16, v133, v132, s8
    s_waitcnt vmcnt(4)
    v_perm_b32 v17, v135, v134, s8
    s_waitcnt vmcnt(2)
    v_perm_b32 v18, v137, v136, s8
    s_waitcnt vmcnt(0)
    v_perm_b32 v19, v139, v138, s8
    v_bfi_b32 v16, s5, v24, v16
    v_perm_b32 v20, v133, v132, s9
    v_bfi_b32 v17, s5, v25, v17
    v_perm_b32 v21, v135, v134, s9
    v_bfi_b32 v18, s5, v26, v18
    v_perm_b32 v22, v137, v136, s9
    v_bfi_b32 v19, s5, v27, v19
    v_perm_b32 v23, v139, v138, s9
    v_bfi_b32 v20, s5, v24, v20
    v_bfi_b32 v21, s5, v25, v21
    v_bfi_b32 v22, s5, v26, v22
    v_bfi_b32 v23, s5, v27, v23
    buffer_store_dwordx4 v[16:19], v131, s[48:51], s26 offen offset:0 sc1
    buffer_store_dwordx4 v[20:23], v131, s[48:51], s26 offen offset:64 sc1
    v_pk_mul_f32 v[192:193], v[172:173], v[166:167] op_sel_hi:[0,1]
    v_pk_fma_f32 v[174:175], v[172:173], v[166:167], v[192:193] op_sel:[1,1,0] op_sel_hi:[1,0,1] neg_lo:[1,0,0]
    v_pk_mul_f32 v[192:193], v[174:175], v[166:167] op_sel_hi:[0,1]
    v_pk_fma_f32 v[176:177], v[174:175], v[166:167], v[192:193] op_sel:[1,1,0] op_sel_hi:[1,0,1] neg_lo:[1,0,0]
    v_pk_mul_f32 v[190:191], v[164:165], v[168:169] op_sel_hi:[0,1]
    v_pk_mul_f32 v[188:189], v[164:165], v[164:165] op_sel_hi:[0,1]
    v_pk_mul_f32 v[192:193], v[176:177], v[166:167] op_sel_hi:[0,1]
    v_pk_fma_f32 v[208:209], v[164:165], v[168:169], v[190:191] op_sel:[1,1,0] op_sel_hi:[1,0,1] neg_lo:[1,0,0]
    v_pk_fma_f32 v[204:205], v[164:165], v[164:165], v[188:189] op_sel:[1,1,0] op_sel_hi:[1,0,1] neg_lo:[1,0,0]
    v_pk_fma_f32 v[178:179], v[176:177], v[166:167], v[192:193] op_sel:[1,1,0] op_sel_hi:[1,0,1] neg_lo:[1,0,0]
    v_cvt_pk_bf16_f32 v199, v208, v209
    v_pk_mul_f32 v[190:191], v[204:205], v[168:169] op_sel_hi:[0,1]
    v_pk_mul_f32 v[188:189], v[204:205], v[164:165] op_sel_hi:[0,1]
    v_pk_mul_f32 v[192:193], v[178:179], v[166:167] op_sel_hi:[0,1]
    v_pk_fma_f32 v[208:209], v[204:205], v[168:169], v[190:191] op_sel:[1,1,0] op_sel_hi:[1,0,1] neg_lo:[1,0,0]
    v_pk_fma_f32 v[206:207], v[204:205], v[164:165], v[188:189] op_sel:[1,1,0] op_sel_hi:[1,0,1] neg_lo:[1,0,0]
    v_pk_fma_f32 v[180:181], v[178:179], v[166:167], v[192:193] op_sel:[1,1,0] op_sel_hi:[1,0,1] neg_lo:[1,0,0]
    v_cvt_pk_bf16_f32 v196, v164, v165
    v_cvt_pk_bf16_f32 v201, v204, v205
    v_pk_mul_f32 v[190:191], v[206:207], v[168:169] op_sel_hi:[0,1]
    v_pk_mul_f32 v[188:189], v[206:207], v[164:165] op_sel_hi:[0,1]
    v_pk_mul_f32 v[192:193], v[180:181], v[166:167] op_sel_hi:[0,1]
    ds_write_addtid_b32 v196 offset:11968
    v_pk_fma_f32 v[210:211], v[206:207], v[168:169], v[190:191] op_sel:[1,1,0] op_sel_hi:[1,0,1] neg_lo:[1,0,0]
    v_pk_fma_f32 v[204:205], v[206:207], v[164:165], v[188:189] op_sel:[1,1,0] op_sel_hi:[1,0,1] neg_lo:[1,0,0]
    v_pk_fma_f32 v[182:183], v[180:181], v[166:167], v[192:193] op_sel:[1,1,0] op_sel_hi:[1,0,1] neg_lo:[1,0,0]
    v_cvt_pk_bf16_f32 v197, v168, v169
    v_cvt_pk_bf16_f32 v202, v208, v209
    v_cvt_pk_bf16_f32 v196, v206, v207
    v_pk_mul_f32 v[190:191], v[204:205], v[168:169] op_sel_hi:[0,1]
    v_pk_mul_f32 v[188:189], v[204:205], v[164:165] op_sel_hi:[0,1]
    v_pk_mul_f32 v[192:193], v[182:183], v[166:167] op_sel_hi:[0,1]
    ds_write_addtid_b32 v197 offset:20128
    v_pk_fma_f32 v[208:209], v[204:205], v[168:169], v[190:191] op_sel:[1,1,0] op_sel_hi:[1,0,1] neg_lo:[1,0,0]
    ds_write_addtid_b32 v199 offset:20672
    v_pk_fma_f32 v[206:207], v[204:205], v[164:165], v[188:189] op_sel:[1,1,0] op_sel_hi:[1,0,1] neg_lo:[1,0,0]
    v_pk_fma_f32 v[184:185], v[182:183], v[166:167], v[192:193] op_sel:[1,1,0] op_sel_hi:[1,0,1] neg_lo:[1,0,0]
    v_cvt_pk_bf16_f32 v200, v174, -v175
    v_cvt_pk_bf16_f32 v197, v210, v211
    v_cvt_pk_bf16_f32 v199, v204, v205
    v_pk_mul_f32 v[190:191], v[206:207], v[168:169] op_sel_hi:[0,1]
    v_pk_mul_f32 v[188:189], v[206:207], v[164:165] op_sel_hi:[0,1]
    v_pk_mul_f32 v[192:193], v[184:185], v[166:167] op_sel_hi:[0,1]
    ds_write_addtid_b32 v200 offset:544
    v_pk_fma_f32 v[210:211], v[206:207], v[168:169], v[190:191] op_sel:[1,1,0] op_sel_hi:[1,0,1] neg_lo:[1,0,0]
    ds_write_addtid_b32 v202 offset:21216
    v_pk_fma_f32 v[204:205], v[206:207], v[164:165], v[188:189] op_sel:[1,1,0] op_sel_hi:[1,0,1] neg_lo:[1,0,0]
    v_pk_fma_f32 v[186:187], v[184:185], v[166:167], v[192:193] op_sel:[1,1,0] op_sel_hi:[1,0,1] neg_lo:[1,0,0]
    v_cvt_pk_bf16_f32 v198, v172, -v173
    v_cvt_pk_bf16_f32 v203, v176, -v177
    v_cvt_pk_bf16_f32 v200, v208, v209
    v_cvt_pk_bf16_f32 v202, v206, v207
    v_pk_mul_f32 v[190:191], v[204:205], v[168:169] op_sel_hi:[0,1]
    v_pk_mul_f32 v[188:189], v[204:205], v[164:165] op_sel_hi:[0,1]
    v_pk_mul_f32 v[192:193], v[172:173], v[170:171] op_sel_hi:[0,1]
    ds_write_addtid_b32 v198 offset:0
    v_pk_fma_f32 v[208:209], v[204:205], v[168:169], v[190:191] op_sel:[1,1,0] op_sel_hi:[1,0,1] neg_lo:[1,0,0]
    ds_write_addtid_b32 v203 offset:1088
    v_pk_fma_f32 v[206:207], v[204:205], v[164:165], v[188:189] op_sel:[1,1,0] op_sel_hi:[1,0,1] neg_lo:[1,0,0]
    ds_write_addtid_b32 v197 offset:21760
    v_pk_fma_f32 v[172:173], v[172:173], v[170:171], v[192:193] op_sel:[1,1,0] op_sel_hi:[1,0,1] neg_lo:[1,0,0]
    v_cvt_pk_bf16_f32 v198, v178, -v179
    v_cvt_pk_bf16_f32 v203, v210, v211
    v_cvt_pk_bf16_f32 v197, v204, v205
    v_pk_mul_f32 v[190:191], v[206:207], v[168:169] op_sel_hi:[0,1]
    v_pk_mul_f32 v[188:189], v[206:207], v[164:165] op_sel_hi:[0,1]
    v_pk_mul_f32 v[192:193], v[176:177], v[170:171] op_sel_hi:[0,1]
    ds_write_addtid_b32 v201 offset:12512
    v_pk_fma_f32 v[210:211], v[206:207], v[168:169], v[190:191] op_sel:[1,1,0] op_sel_hi:[1,0,1] neg_lo:[1,0,0]
    ds_write_addtid_b32 v198 offset:1632
    v_pk_fma_f32 v[204:205], v[206:207], v[164:165], v[188:189] op_sel:[1,1,0] op_sel_hi:[1,0,1] neg_lo:[1,0,0]
    ds_write_addtid_b32 v200 offset:22304
    v_pk_fma_f32 v[176:177], v[176:177], v[170:171], v[192:193] op_sel:[1,1,0] op_sel_hi:[1,0,1] neg_lo:[1,0,0]
    v_cvt_pk_bf16_f32 v201, v180, -v181
    v_cvt_pk_bf16_f32 v198, v208, v209
    v_cvt_pk_bf16_f32 v200, v206, v207
    v_pk_mul_f32 v[190:191], v[204:205], v[168:169] op_sel_hi:[0,1]
    v_pk_mul_f32 v[188:189], v[204:205], v[164:165] op_sel_hi:[0,1]
    v_pk_mul_f32 v[192:193], v[180:181], v[170:171] op_sel_hi:[0,1]
    ds_write_addtid_b32 v196 offset:13056
    v_pk_fma_f32 v[208:209], v[204:205], v[168:169], v[190:191] op_sel:[1,1,0] op_sel_hi:[1,0,1] neg_lo:[1,0,0]
    ds_write_addtid_b32 v199 offset:13600
    v_pk_fma_f32 v[206:207], v[204:205], v[164:165], v[188:189] op_sel:[1,1,0] op_sel_hi:[1,0,1] neg_lo:[1,0,0]
    ds_write_addtid_b32 v201 offset:2176
    v_pk_fma_f32 v[180:181], v[180:181], v[170:171], v[192:193] op_sel:[1,1,0] op_sel_hi:[1,0,1] neg_lo:[1,0,0]
    ds_write_addtid_b32 v203 offset:22848
    v_cvt_pk_bf16_f32 v196, v182, -v183
    v_cvt_pk_bf16_f32 v199, v184, -v185
    v_cvt_pk_bf16_f32 v201, v210, v211
    v_cvt_pk_bf16_f32 v203, v204, v205
    v_pk_mul_f32 v[190:191], v[206:207], v[168:169] op_sel_hi:[0,1]
    v_pk_mul_f32 v[188:189], v[206:207], v[164:165] op_sel_hi:[0,1]
    v_pk_mul_f32 v[192:193], v[184:185], v[170:171] op_sel_hi:[0,1]
    ds_write_addtid_b32 v196 offset:2720
    v_pk_fma_f32 v[210:211], v[206:207], v[168:169], v[190:191] op_sel:[1,1,0] op_sel_hi:[1,0,1] neg_lo:[1,0,0]
    ds_write_addtid_b32 v197 offset:14688
    v_pk_fma_f32 v[204:205], v[206:207], v[164:165], v[188:189] op_sel:[1,1,0] op_sel_hi:[1,0,1] neg_lo:[1,0,0]
    ds_write_addtid_b32 v198 offset:23392
    v_pk_fma_f32 v[184:185], v[184:185], v[170:171], v[192:193] op_sel:[1,1,0] op_sel_hi:[1,0,1] neg_lo:[1,0,0]
    v_cvt_pk_bf16_f32 v196, v208, v209
    v_cvt_pk_bf16_f32 v197, v172, -v173
    v_cvt_pk_bf16_f32 v198, v206, v207
    v_pk_mul_f32 v[190:191], v[204:205], v[168:169] op_sel_hi:[0,1]
    v_pk_mul_f32 v[188:189], v[204:205], v[164:165] op_sel_hi:[0,1]
    v_pk_mul_f32 v[192:193], v[172:173], v[170:171] op_sel_hi:[0,1]
    ds_write_addtid_b32 v202 offset:14144
    v_pk_fma_f32 v[208:209], v[204:205], v[168:169], v[190:191] op_sel:[1,1,0] op_sel_hi:[1,0,1] neg_lo:[1,0,0]
    ds_write_addtid_b32 v199 offset:3264
    v_pk_fma_f32 v[206:207], v[204:205], v[164:165], v[188:189] op_sel:[1,1,0] op_sel_hi:[1,0,1] neg_lo:[1,0,0]
    ds_write_addtid_b32 v201 offset:23936
    v_pk_fma_f32 v[172:173], v[172:173], v[170:171], v[192:193] op_sel:[1,1,0] op_sel_hi:[1,0,1] neg_lo:[1,0,0]
    ds_write_addtid_b32 v203 offset:15776
    v_cvt_pk_bf16_f32 v202, v186, -v187
    v_cvt_pk_bf16_f32 v199, v210, v211
    v_cvt_pk_bf16_f32 v201, v204, v205
    v_cvt_pk_bf16_f32 v203, v180, -v181
    v_pk_mul_f32 v[190:191], v[206:207], v[168:169] op_sel_hi:[0,1]
    v_pk_mul_f32 v[188:189], v[206:207], v[164:165] op_sel_hi:[0,1]
    v_pk_mul_f32 v[192:193], v[180:181], v[170:171] op_sel_hi:[0,1]
    ds_write_addtid_b32 v202 offset:3808
    v_pk_fma_f32 v[210:211], v[206:207], v[168:169], v[190:191] op_sel:[1,1,0] op_sel_hi:[1,0,1] neg_lo:[1,0,0]
    ds_write_addtid_b32 v196 offset:24480
    v_pk_fma_f32 v[204:205], v[206:207], v[164:165], v[188:189] op_sel:[1,1,0] op_sel_hi:[1,0,1] neg_lo:[1,0,0]
    ds_write_addtid_b32 v201 offset:16864
    v_pk_fma_f32 v[180:181], v[180:181], v[170:171], v[192:193] op_sel:[1,1,0] op_sel_hi:[1,0,1] neg_lo:[1,0,0]
    v_cvt_pk_bf16_f32 v202, v208, v209
    v_cvt_pk_bf16_f32 v196, v206, v207
    v_pk_mul_f32 v[190:191], v[204:205], v[168:169] op_sel_hi:[0,1]
    v_cvt_pk_bf16_f32 v201, v172, -v173
    v_pk_mul_f32 v[188:189], v[204:205], v[164:165] op_sel_hi:[0,1]
    v_pk_mul_f32 v[192:193], v[172:173], v[170:171] op_sel_hi:[0,1]
    ds_write_addtid_b32 v197 offset:4352
    v_pk_fma_f32 v[208:209], v[204:205], v[168:169], v[190:191] op_sel:[1,1,0] op_sel_hi:[1,0,1] neg_lo:[1,0,0]
    ds_write_addtid_b32 v199 offset:25024
    v_pk_fma_f32 v[206:207], v[204:205], v[164:165], v[188:189] op_sel:[1,1,0] op_sel_hi:[1,0,1] neg_lo:[1,0,0]
    ds_write_addtid_b32 v196 offset:17408
    v_pk_fma_f32 v[172:173], v[172:173], v[170:171], v[192:193] op_sel:[1,1,0] op_sel_hi:[1,0,1] neg_lo:[1,0,0]
    v_cvt_pk_bf16_f32 v197, v210, v211
    v_cvt_pk_bf16_f32 v199, v204, v205
    v_pk_mul_f32 v[190:191], v[206:207], v[168:169] op_sel_hi:[0,1]
    v_cvt_pk_bf16_f32 v196, v180, -v181
    v_pk_mul_f32 v[192:193], v[180:181], v[170:171] op_sel_hi:[0,1]
    ds_write_addtid_b32 v203 offset:5440
    v_pk_fma_f32 v[210:211], v[206:207], v[168:169], v[190:191] op_sel:[1,1,0] op_sel_hi:[1,0,1] neg_lo:[1,0,0]
    ds_write_addtid_b32 v199 offset:17952
    v_pk_fma_f32 v[180:181], v[180:181], v[170:171], v[192:193] op_sel:[1,1,0] op_sel_hi:[1,0,1] neg_lo:[1,0,0]
    v_cvt_pk_bf16_f32 v203, v210, v211
    v_cvt_pk_bf16_f32 v199, v172, -v173
    v_pk_mul_f32 v[192:193], v[172:173], v[170:171] op_sel_hi:[0,1]
    ds_write_addtid_b32 v200 offset:15232
    v_pk_fma_f32 v[172:173], v[172:173], v[170:171], v[192:193] op_sel:[1,1,0] op_sel_hi:[1,0,1] neg_lo:[1,0,0]
    ds_write_addtid_b32 v203 offset:27200
    v_cvt_pk_bf16_f32 v200, v176, -v177
    v_pk_mul_f32 v[188:189], v[206:207], v[164:165] op_sel_hi:[0,1]
    v_cvt_pk_bf16_f32 v203, v172, -v173
    v_pk_mul_f32 v[192:193], v[172:173], v[170:171] op_sel_hi:[0,1]
    ds_write_addtid_b32 v198 offset:16320
    v_pk_fma_f32 v[204:205], v[206:207], v[164:165], v[188:189] op_sel:[1,1,0] op_sel_hi:[1,0,1] neg_lo:[1,0,0]
    ds_write_addtid_b32 v200 offset:4896
    v_pk_fma_f32 v[172:173], v[172:173], v[170:171], v[192:193] op_sel:[1,1,0] op_sel_hi:[1,0,1] neg_lo:[1,0,0]
    ds_write_addtid_b32 v197 offset:26112
    v_cvt_pk_bf16_f32 v198, v184, -v185
    ds_write_addtid_b32 v196 offset:7072
    v_cvt_pk_bf16_f32 v200, v208, v209
    v_pk_mul_f32 v[190:191], v[204:205], v[168:169] op_sel_hi:[0,1]
    v_cvt_pk_bf16_f32 v197, v204, v205
    v_cvt_pk_bf16_f32 v196, v172, -v173
    v_pk_mul_f32 v[192:193], v[172:173], v[170:171] op_sel_hi:[0,1]
    ds_write_addtid_b32 v202 offset:25568
    v_pk_fma_f32 v[208:209], v[204:205], v[168:169], v[190:191] op_sel:[1,1,0] op_sel_hi:[1,0,1] neg_lo:[1,0,0]
    ds_write_addtid_b32 v198 offset:5984
    v_pk_fma_f32 v[172:173], v[172:173], v[170:171], v[192:193] op_sel:[1,1,0] op_sel_hi:[1,0,1] neg_lo:[1,0,0]
    ds_write_addtid_b32 v197 offset:19040
    v_cvt_pk_bf16_f32 v202, v206, v207
    v_cvt_pk_bf16_f32 v198, v208, v209
    v_pk_mul_f32 v[188:189], v[204:205], v[164:165] op_sel_hi:[0,1]
    v_cvt_pk_bf16_f32 v197, v172, -v173
    v_pk_mul_f32 v[192:193], v[172:173], v[170:171] op_sel_hi:[0,1]
    ds_write_addtid_b32 v198 offset:27744
    v_pk_fma_f32 v[206:207], v[204:205], v[164:165], v[188:189] op_sel:[1,1,0] op_sel_hi:[1,0,1] neg_lo:[1,0,0]
    v_pk_fma_f32 v[172:173], v[172:173], v[170:171], v[192:193] op_sel:[1,1,0] op_sel_hi:[1,0,1] neg_lo:[1,0,0]
    v_pk_mul_f32 v[190:191], v[206:207], v[168:169] op_sel_hi:[0,1]
    v_cvt_pk_bf16_f32 v198, v172, -v173
    v_pk_mul_f32 v[192:193], v[172:173], v[170:171] op_sel_hi:[0,1]
    ds_write_addtid_b32 v200 offset:26656
    v_pk_fma_f32 v[210:211], v[206:207], v[168:169], v[190:191] op_sel:[1,1,0] op_sel_hi:[1,0,1] neg_lo:[1,0,0]
    ds_write_addtid_b32 v201 offset:6528
    v_pk_fma_f32 v[172:173], v[172:173], v[170:171], v[192:193] op_sel:[1,1,0] op_sel_hi:[1,0,1] neg_lo:[1,0,0]
    ds_write_addtid_b32 v202 offset:18496
    v_cvt_pk_bf16_f32 v200, v206, v207
    ds_write_addtid_b32 v199 offset:7616
    v_cvt_pk_bf16_f32 v201, v210, v211
    v_cvt_pk_bf16_f32 v202, v180, -v181
    v_cvt_pk_bf16_f32 v199, v172, -v173
    ds_write_addtid_b32 v200 offset:19584
    ds_write_addtid_b32 v203 offset:8704
    ds_write_addtid_b32 v196 offset:9248
    ds_write_addtid_b32 v197 offset:9792
    ds_write_addtid_b32 v198 offset:10336
    ds_write_addtid_b32 v201 offset:28288
    ds_write_addtid_b32 v202 offset:8160
    ds_write_addtid_b32 v199 offset:10880
    s_waitcnt lgkmcnt(0)
    s_barrier
    ds_read_b128 v[128:131], v42 offset:0
    ds_read_b128 v[132:135], v41 offset:0
    ds_read_b128 v[136:139], v41 offset:8704
    ds_read_b128 v[140:143], v42 offset:64
    ds_read_b128 v[144:147], v41 offset:64
    ds_read_b128 v[148:151], v41 offset:8768
    ds_read_b128 v[152:155], v42 offset:128
    ds_read_b128 v[156:159], v41 offset:128
    ds_read_b128 v[160:163], v41 offset:8832
    s_waitcnt lgkmcnt(7)
    v_mfma_f32_16x16x32_bf16 v[72:75], v[132:135], v[128:131], 0
    ds_read_b128 v[164:167], v42 offset:192
    s_waitcnt lgkmcnt(7)
    v_mfma_f32_16x16x32_bf16 v[76:79], v[136:139], v[128:131], 0
    ds_read_b128 v[168:171], v41 offset:192
    ds_read_b128 v[172:175], v41 offset:8896
    s_waitcnt lgkmcnt(7)
    v_mfma_f32_16x16x32_bf16 v[72:75], v[144:147], v[140:143], v[72:75]
    ds_read_b128 v[176:179], v42 offset:256
    s_waitcnt lgkmcnt(7)
    v_mfma_f32_16x16x32_bf16 v[76:79], v[148:151], v[140:143], v[76:79]
    ds_read_b128 v[180:183], v41 offset:256
    ds_read_b128 v[184:187], v41 offset:8960
    s_waitcnt lgkmcnt(7)
    v_mfma_f32_16x16x32_bf16 v[72:75], v[156:159], v[152:155], v[72:75]
    ds_read_b128 v[188:191], v42 offset:320
    s_waitcnt lgkmcnt(7)
    v_mfma_f32_16x16x32_bf16 v[76:79], v[160:163], v[152:155], v[76:79]
    ds_read_b128 v[192:195], v41 offset:320
    ds_read_b128 v[196:199], v41 offset:9024
    s_waitcnt lgkmcnt(7)
    v_mfma_f32_16x16x32_bf16 v[72:75], v[168:171], v[164:167], v[72:75]
    ds_read_b128 v[200:203], v42 offset:384
    s_waitcnt lgkmcnt(7)
    v_mfma_f32_16x16x32_bf16 v[76:79], v[172:175], v[164:167], v[76:79]
    ds_read_b128 v[204:207], v41 offset:384
    ds_read_b128 v[208:211], v41 offset:9088
    s_waitcnt lgkmcnt(7)
    v_mfma_f32_16x16x32_bf16 v[72:75], v[180:183], v[176:179], v[72:75]
    ds_read_b128 v[212:215], v42 offset:448
    s_waitcnt lgkmcnt(7)
    v_mfma_f32_16x16x32_bf16 v[76:79], v[184:187], v[176:179], v[76:79]
    ds_read_b128 v[216:219], v41 offset:448
    ds_read_b128 v[220:223], v41 offset:9152
    s_waitcnt lgkmcnt(7)
    v_mfma_f32_16x16x32_bf16 v[72:75], v[192:195], v[188:191], v[72:75]
    s_waitcnt lgkmcnt(6)
    v_mfma_f32_16x16x32_bf16 v[76:79], v[196:199], v[188:191], v[76:79]
    s_waitcnt lgkmcnt(4)
    v_mfma_f32_16x16x32_bf16 v[72:75], v[204:207], v[200:203], v[72:75]
    s_waitcnt lgkmcnt(3)
    v_mfma_f32_16x16x32_bf16 v[76:79], v[208:211], v[200:203], v[76:79]
    s_waitcnt lgkmcnt(1)
    v_mfma_f32_16x16x32_bf16 v[72:75], v[216:219], v[212:215], v[72:75]
    s_waitcnt lgkmcnt(0)
    v_mfma_f32_16x16x32_bf16 v[76:79], v[220:223], v[212:215], v[76:79]
    s_nop 5
    v_cvt_pk_bf16_f32 v80, v72, v73
    v_cvt_pk_bf16_f32 v81, v74, v75
    ds_write_b16 v43, v80
    v_cvt_pk_bf16_f32 v82, v76, v77
    v_cvt_pk_bf16_f32 v83, v78, v79
    ds_write_b16_d16_hi v44, v80
    ds_write_b16 v45, v81
    ds_write_b16_d16_hi v46, v81
    ds_write_b16 v47, v82
    ds_write_b16_d16_hi v48, v82 offset:64
    ds_write_b16 v48, v83 offset:128
    ds_write_b16_d16_hi v48, v83 offset:192
    s_waitcnt lgkmcnt(0)
    s_barrier
    ds_read_u16 v36, v36
    ds_read_u16 v35, v35
    ds_read_u16 v34, v34
    ds_read_u16 v33, v33
    ds_read_u16 v32, v32
    ds_read_u16 v31, v31
    ds_read_u16 v30, v30
    ds_read_u16 v29, v29
    ds_read_u16 v28, v28
    ds_read_u16 v39, v39
    buffer_load_dwordx4 v[16:19], v12, s[48:51], s52 offen sc1
    buffer_load_dwordx4 v[20:23], v12, s[48:51], s53 offen sc1
    s_waitcnt lgkmcnt(8)
    v_lshl_or_b32 v128, v35, 16, v36
    s_waitcnt lgkmcnt(7)
    v_lshl_or_b32 v132, v34, 16, v35
    s_waitcnt lgkmcnt(6)
    v_lshl_or_b32 v129, v33, 16, v34
    s_waitcnt lgkmcnt(5)
    v_lshl_or_b32 v133, v32, 16, v33
    s_waitcnt lgkmcnt(4)
    v_lshl_or_b32 v130, v31, 16, v32
    s_waitcnt lgkmcnt(3)
    v_lshl_or_b32 v134, v30, 16, v31
    s_waitcnt lgkmcnt(2)
    v_lshl_or_b32 v131, v29, 16, v30
    s_waitcnt lgkmcnt(1)
    v_lshl_or_b32 v135, v28, 16, v29
    ds_write_b128 v38, v[128:131] offset:64
    ds_write_b128 v38, v[132:135] offset:2304
    s_waitcnt lgkmcnt(2)
    v_mul_u32_u24 v39, v39, v40
    ds_write_b32 v53, v39 offset:0
    s_lshl_b32 s13, s7, 1
    v_xor_b32 v59, s13, v1
    s_lshl_b32 s13, s7, 8
    v_lshlrev_b32 v3, 3, v2
    s_mul_i32 s12, s6, 4608
    s_sub_u32 s12, s12, s13
    v_sub_u32 v4, v3, v1
    s_add_u32 s12, s12, 63904
    v_add_u32 v4, 1039, v4
    s_mul_i32 s17, s6, 4480
    v_and_b32 v246, 1, v4
    s_sub_u32 s17, s17, s13
    v_mul_u32_u24 v246, 2240, v246
    v_lshrrev_b32 v4, 1, v4
    v_and_b32 v245, 3, v0
    s_add_u32 s17, s17, -704
    v_lshl_add_u32 v50, v4, 2, v246
    v_lshlrev_b32 v245, 2, v245
    v_lshlrev_b32 v49, 5, v59
    v_add_u32 v50, s17, v50
    s_cmp_eq_u32 s7, 0
    v_lshrrev_b32 v68, v245, s4
    v_lshl_add_u32 v49, v2, 4, v49
    v_add_u32 v52, -1344, v50
    v_mov_b32 v246, 63616
    s_cselect_b64 s[30:31], -1, 0
    v_lshrrev_b32 v69, 1, v68
    v_lshrrev_b32 v70, 2, v68
    v_lshrrev_b32 v71, 3, v68
    v_add_u32 v49, s12, v49
    v_add_u32 v51, -1024, v50
    v_cndmask_b32 v52, v246, v52, s[30:31]
    s_mov_b32 s5, 0x10001
    v_and_b32 v68, 0x10001, v68
    v_and_b32 v69, 0x10001, v69
    v_and_b32 v70, 0x10001, v70
    v_and_b32 v71, 0x10001, v71
    s_mov_b32 s59, 30000
L_tag1:
    s_waitcnt vmcnt(1)
    v_xor_b32 v16, v68, v16
    v_xor_b32 v17, v69, v17
    v_xor_b32 v18, v70, v18
    v_xor_b32 v19, v71, v19
    v_or3_b32 v13, v16, v17, v18
    v_or_b32 v13, v13, v19
    s_waitcnt vmcnt(0)
    v_xor_b32 v20, v68, v20
    v_xor_b32 v21, v69, v21
    v_xor_b32 v22, v70, v22
    v_xor_b32 v23, v71, v23
    v_or3_b32 v13, v13, v20, v21
    v_or3_b32 v13, v13, v22, v23
    v_and_b32 v13, 0x10001, v13
    v_cmp_ne_u32 vcc, 0, v13
    s_cbranch_vccz L_tag1_out
    s_sub_u32 s59, s59, 1
    s_cbranch_scc1 L_tag1_out
    s_wqm_b64 exec, vcc
    s_sleep 4
    buffer_load_dwordx4 v[16:19], v12, s[48:51], s52 offen sc1
    buffer_load_dwordx4 v[20:23], v12, s[48:51], s53 offen sc1
    s_branch L_tag1
L_tag1_out:
    s_mov_b64 exec, -1
    ds_write_b128 v54, v[16:19]
    ds_write_b128 v54, v[20:23] offset:2048
    s_setprio 2
    s_waitcnt lgkmcnt(0)
    s_barrier
    ds_read2_b32 v[160:161], v50 offset0:176 offset1:177
    ds_read2_b32 v[162:163], v50 offset0:178 offset1:179
    ds_read_b128 v[128:131], v49 offset:192
    ds_read2_b32 v[164:165], v50 offset0:48 offset1:49
    ds_read2_b32 v[166:167], v50 offset0:50 offset1:51
    ds_read_b128 v[132:135], v49 offset:704
    ds_read2_b32 v[168:169], v51 offset0:176 offset1:177
    ds_read2_b32 v[170:171], v51 offset0:178 offset1:179
    ds_read_b128 v[136:139], v49 offset:1216
    ds_read2_b32 v[172:173], v51 offset0:48 offset1:49
    ds_read2_b32 v[174:175], v51 offset0:50 offset1:51
    ds_read_b128 v[140:143], v49 offset:1728
    ds_read_b128 v[144:147], v49 offset:2240
    ds_read_b128 v[148:151], v49 offset:2752
    ds_read_b128 v[152:155], v49 offset:3264
    ds_read_b128 v[156:159], v49 offset:3776
    ds_read2_b32 v[224:225], v52 offset0:0 offset1:1
    ds_read2_b32 v[226:227], v52 offset0:2 offset1:3
    v_lshlrev_b32 v4, 5, v1
    v_lshl_add_u32 v4, v2, 4, v4
    s_mul_i32 s29, s7, 768
    s_add_u32 s29, s29, s12
    s_add_u32 s29, s29, 176
    v_add_u32 v57, s29, v4
    s_sub_u32 s29, s12, s13
    s_add_u32 s29, s29, 1712
    v_add_u32 v58, s29, v4
    v_lshlrev_b32 v4, 2, v2
    v_sub_u32 v4, v59, v4
    v_lshlrev_b32 v4, 2, v4
    s_lshl_b32 s13, s7, 6
    s_sub_u32 s29, s19, s13
    s_add_u32 s29, s29, 116
    v_add_u32 v55, s29, v4
    s_add_u32 s29, s19, s13
    s_sub_u32 s29, s29, 76
    v_add_u32 v56, s29, v4
    v_mov_b32 v4, 4064
    v_lshlrev_b32 v4, v1, v4
    v_lshrrev_b32 v4, v3, v4
    v_bfe_u32 v60, v4, 0, 2
    v_mul_u32_u24 v60, 0x8001, v60
    s_waitcnt lgkmcnt(15)
    v_mfma_f32_16x16x32_bf16 v[72:75], v[128:131], v[160:163], 0
    v_and_b32 v60, 0x10001, v60
    s_waitcnt lgkmcnt(13)
    v_mfma_f32_16x16x32_bf16 v[76:79], v[128:131], v[164:167], 0
    v_mul_u32_u24 v60, 0x3f80, v60
    s_waitcnt lgkmcnt(12)
    v_mfma_f32_16x16x32_bf16 v[76:79], v[132:135], v[160:163], v[76:79]
    v_bfe_u32 v61, v4, 2, 2
    v_mfma_f32_16x16x32_bf16 v[80:83], v[132:135], v[164:167], 0
    v_mul_u32_u24 v61, 0x8001, v61
    s_waitcnt lgkmcnt(10)
    v_mfma_f32_16x16x32_bf16 v[80:83], v[128:131], v[168:171], v[80:83]
    ds_read2_b32 v[208:209], v50 offset0:160 offset1:161
    v_and_b32 v61, 0x10001, v61
    s_waitcnt lgkmcnt(10)
    v_mfma_f32_16x16x32_bf16 v[80:83], v[136:139], v[160:163], v[80:83]
    ds_read2_b32 v[210:211], v50 offset0:162 offset1:163
    v_mul_u32_u24 v61, 0x3f80, v61
    v_mfma_f32_16x16x32_bf16 v[84:87], v[132:135], v[168:171], 0
    ds_read_b128 v[176:179], v49 offset:128
    v_bfe_u32 v62, v4, 4, 2
    v_mfma_f32_16x16x32_bf16 v[84:87], v[136:139], v[164:167], v[84:87]
    ds_read2_b32 v[212:213], v50 offset0:32 offset1:33
    v_mul_u32_u24 v62, 0x8001, v62
    v_mfma_f32_16x16x32_bf16 v[88:91], v[136:139], v[168:171], 0
    ds_read2_b32 v[214:215], v50 offset0:34 offset1:35
    v_and_b32 v62, 0x10001, v62
    s_waitcnt lgkmcnt(12)
    v_mfma_f32_16x16x32_bf16 v[84:87], v[128:131], v[172:175], v[84:87]
    ds_read_b128 v[180:183], v49 offset:640
    v_mul_u32_u24 v62, 0x3f80, v62
    s_waitcnt lgkmcnt(12)
    v_mfma_f32_16x16x32_bf16 v[84:87], v[140:143], v[160:163], v[84:87]
    ds_read2_b32 v[216:217], v51 offset0:160 offset1:161
    v_bfe_u32 v63, v4, 6, 2
    v_mfma_f32_16x16x32_bf16 v[88:91], v[132:135], v[172:175], v[88:91]
    ds_read2_b32 v[218:219], v51 offset0:162 offset1:163
    v_mul_u32_u24 v63, 0x8001, v63
    v_mfma_f32_16x16x32_bf16 v[88:91], v[140:143], v[164:167], v[88:91]
    ds_read_b128 v[184:187], v49 offset:1152
    v_and_b32 v63, 0x10001, v63
    v_mfma_f32_16x16x32_bf16 v[92:95], v[136:139], v[172:175], 0
    ds_read2_b32 v[220:221], v51 offset0:32 offset1:33
    v_mul_u32_u24 v63, 0x3f80, v63
    v_mfma_f32_16x16x32_bf16 v[92:95], v[140:143], v[168:171], v[92:95]
    ds_read2_b32 v[222:223], v51 offset0:34 offset1:35
    v_mov_b32 v4, 8176
    v_mfma_f32_16x16x32_bf16 v[96:99], v[140:143], v[172:175], 0
    ds_read_b128 v[188:191], v49 offset:1664
    v_lshlrev_b32 v4, v1, v4
    s_waitcnt lgkmcnt(15)
    v_mfma_f32_16x16x32_bf16 v[88:91], v[144:147], v[160:163], v[88:91]
    ds_read_b128 v[192:195], v49 offset:2176
    v_lshrrev_b32 v4, v3, v4
    v_mfma_f32_16x16x32_bf16 v[92:95], v[144:147], v[164:167], v[92:95]
    ds_read_b128 v[196:199], v49 offset:2688
    v_bfe_u32 v64, v4, 0, 2
    v_mfma_f32_16x16x32_bf16 v[96:99], v[144:147], v[168:171], v[96:99]
    ds_read_b128 v[200:203], v49 offset:3200
    v_mul_u32_u24 v64, 0x8001, v64
    v_mfma_f32_16x16x32_bf16 v[100:103], v[144:147], v[172:175], 0
    ds_read_b128 v[204:207], v49 offset:3712
    v_and_b32 v64, 0x10001, v64
    v_mfma_f32_16x16x32_bf16 v[92:95], v[148:151], v[160:163], v[92:95]
    v_mul_u32_u24 v64, 0x3f80, v64
    v_mfma_f32_16x16x32_bf16 v[96:99], v[148:151], v[164:167], v[96:99]
    v_bfe_u32 v65, v4, 2, 2
    v_mfma_f32_16x16x32_bf16 v[100:103], v[148:151], v[168:171], v[100:103]
    v_mul_u32_u24 v65, 0x8001, v65
    v_mfma_f32_16x16x32_bf16 v[96:99], v[152:155], v[160:163], v[96:99]
    v_and_b32 v65, 0x10001, v65
    v_mfma_f32_16x16x32_bf16 v[100:103], v[152:155], v[164:167], v[100:103]
    v_mul_u32_u24 v65, 0x3f80, v65
    s_waitcnt lgkmcnt(15)
    v_mfma_f32_16x16x32_bf16 v[100:103], v[156:159], v[160:163], v[100:103]
    v_bfe_u32 v66, v4, 4, 2
    v_mfma_f32_16x16x32_bf16 v[88:91], v[128:131], v[224:227], v[88:91]
    v_mul_u32_u24 v66, 0x8001, v66
    v_mfma_f32_16x16x32_bf16 v[92:95], v[132:135], v[224:227], v[92:95]
    v_and_b32 v66, 0x10001, v66
    v_mfma_f32_16x16x32_bf16 v[96:99], v[136:139], v[224:227], v[96:99]
    v_mul_u32_u24 v66, 0x3f80, v66
    v_mfma_f32_16x16x32_bf16 v[100:103], v[140:143], v[224:227], v[100:103]
    v_bfe_u32 v67, v4, 6, 2
    s_waitcnt lgkmcnt(13)
    v_mfma_f32_16x16x32_bf16 v[72:75], v[176:179], v[208:211], v[72:75]
    ds_read_b128 v[228:231], v57 offset:16
    v_mul_u32_u24 v67, 0x8001, v67
    s_waitcnt lgkmcnt(12)
    v_mfma_f32_16x16x32_bf16 v[76:79], v[176:179], v[212:215], v[76:79]
    ds_read_b128 v[232:235], v57
    v_and_b32 v67, 0x10001, v67
    s_waitcnt lgkmcnt(12)
    v_mfma_f32_16x16x32_bf16 v[76:79], v[180:183], v[208:211], v[76:79]
    ds_read_b128 v[236:239], v58 offset:16
    v_mul_u32_u24 v67, 0x3f80, v67
    v_mfma_f32_16x16x32_bf16 v[80:83], v[180:183], v[212:215], v[80:83]
    ds_read_b128 v[240:243], v58
    s_waitcnt lgkmcnt(12)
    v_mfma_f32_16x16x32_bf16 v[80:83], v[176:179], v[216:219], v[80:83]
    ds_read2_b32 v[160:161], v50 offset0:144 offset1:145
    s_waitcnt lgkmcnt(12)
    v_mfma_f32_16x16x32_bf16 v[80:83], v[184:187], v[208:211], v[80:83]
    ds_read2_b32 v[162:163], v50 offset0:146 offset1:147
    v_mfma_f32_16x16x32_bf16 v[84:87], v[180:183], v[216:219], v[84:87]
    ds_read_b128 v[128:131], v49 offset:64
    v_mfma_f32_16x16x32_bf16 v[84:87], v[184:187], v[212:215], v[84:87]
    ds_read2_b32 v[164:165], v50 offset0:16 offset1:17
    v_mfma_f32_16x16x32_bf16 v[88:91], v[184:187], v[216:219], v[88:91]
    ds_read2_b32 v[166:167], v50 offset0:18 offset1:19
    s_waitcnt lgkmcnt(14)
    v_mfma_f32_16x16x32_bf16 v[84:87], v[176:179], v[220:223], v[84:87]
    ds_read_b128 v[132:135], v49 offset:576
    s_waitcnt lgkmcnt(14)
    v_mfma_f32_16x16x32_bf16 v[84:87], v[188:191], v[208:211], v[84:87]
    ds_read2_b32 v[168:169], v51 offset0:144 offset1:145
    v_mfma_f32_16x16x32_bf16 v[88:91], v[180:183], v[220:223], v[88:91]
    ds_read2_b32 v[170:171], v51 offset0:146 offset1:147
    v_mfma_f32_16x16x32_bf16 v[88:91], v[188:191], v[212:215], v[88:91]
    ds_read_b128 v[136:139], v49 offset:1088
    v_mfma_f32_16x16x32_bf16 v[92:95], v[184:187], v[220:223], v[92:95]
    ds_read2_b32 v[172:173], v51 offset0:16 offset1:17
    v_mfma_f32_16x16x32_bf16 v[92:95], v[188:191], v[216:219], v[92:95]
    ds_read2_b32 v[174:175], v51 offset0:18 offset1:19
    v_mfma_f32_16x16x32_bf16 v[96:99], v[188:191], v[220:223], v[96:99]
    ds_read_b128 v[140:143], v49 offset:1600
    s_waitcnt lgkmcnt(15)
    v_mfma_f32_16x16x32_bf16 v[88:91], v[192:195], v[208:211], v[88:91]
    ds_read_b128 v[144:147], v49 offset:2112
    v_mfma_f32_16x16x32_bf16 v[92:95], v[192:195], v[212:215], v[92:95]
    ds_read_b128 v[148:151], v49 offset:2624
    v_mfma_f32_16x16x32_bf16 v[96:99], v[192:195], v[216:219], v[96:99]
    ds_read_b128 v[152:155], v49 offset:3136
    v_mfma_f32_16x16x32_bf16 v[100:103], v[192:195], v[220:223], v[100:103]
    ds_read_b128 v[156:159], v49 offset:3648
    v_mfma_f32_16x16x32_bf16 v[92:95], v[196:199], v[208:211], v[92:95]
    v_mfma_f32_16x16x32_bf16 v[96:99], v[196:199], v[212:215], v[96:99]
    v_mfma_f32_16x16x32_bf16 v[100:103], v[196:199], v[216:219], v[100:103]
    v_mfma_f32_16x16x32_bf16 v[96:99], v[200:203], v[208:211], v[96:99]
    v_mfma_f32_16x16x32_bf16 v[100:103], v[200:203], v[212:215], v[100:103]
    v_mfma_f32_16x16x32_bf16 v[100:103], v[204:207], v[208:211], v[100:103]
    v_mfma_f32_16x16x32_bf16 v[104:107], v[228:231], v[60:63], 0
    s_waitcnt lgkmcnt(15)
    v_mfma_f32_16x16x32_bf16 v[108:111], v[232:235], v[64:67], 0
    v_mfma_f32_16x16x32_bf16 v[112:115], v[236:239], v[60:63], 0
    v_mfma_f32_16x16x32_bf16 v[116:119], v[240:243], v[64:67], 0
    s_waitcnt lgkmcnt(13)
    v_mfma_f32_16x16x32_bf16 v[72:75], v[128:131], v[160:163], v[72:75]
    ds_read2_b32 v[208:209], v50 offset0:128 offset1:129
    s_waitcnt lgkmcnt(12)
    v_mfma_f32_16x16x32_bf16 v[76:79], v[128:131], v[164:167], v[76:79]
    ds_read2_b32 v[210:211], v50 offset0:130 offset1:131
    ds_read_b128 v[176:179], v49 offset:0
    s_waitcnt lgkmcnt(13)
    v_mfma_f32_16x16x32_bf16 v[76:79], v[132:135], v[160:163], v[76:79]
    ds_read2_b32 v[212:213], v50 offset0:0 offset1:1
    v_mfma_f32_16x16x32_bf16 v[80:83], v[132:135], v[164:167], v[80:83]
    ds_read2_b32 v[214:215], v50 offset0:2 offset1:3
    ds_read_b128 v[180:183], v49 offset:512
    s_waitcnt lgkmcnt(14)
    v_mfma_f32_16x16x32_bf16 v[80:83], v[128:131], v[168:171], v[80:83]
    ds_read2_b32 v[216:217], v51 offset0:128 offset1:129
    s_waitcnt lgkmcnt(14)
    v_mfma_f32_16x16x32_bf16 v[80:83], v[136:139], v[160:163], v[80:83]
    ds_read2_b32 v[218:219], v51 offset0:130 offset1:131
    ds_read_b128 v[184:187], v49 offset:1024
    v_mfma_f32_16x16x32_bf16 v[84:87], v[132:135], v[168:171], v[84:87]
    ds_read2_b32 v[220:221], v51 offset0:0 offset1:1
    v_mfma_f32_16x16x32_bf16 v[84:87], v[136:139], v[164:167], v[84:87]
    ds_read2_b32 v[222:223], v51 offset0:2 offset1:3
    ds_read_b128 v[188:191], v49 offset:1536
    v_mfma_f32_16x16x32_bf16 v[88:91], v[136:139], v[168:171], v[88:91]
    ds_read_b128 v[192:195], v49 offset:2048
    s_waitcnt lgkmcnt(15)
    v_mfma_f32_16x16x32_bf16 v[84:87], v[128:131], v[172:175], v[84:87]
    ds_read_b128 v[196:199], v49 offset:2560
    ds_read_b128 v[200:203], v49 offset:3072
    v_mfma_f32_16x16x32_bf16 v[84:87], v[140:143], v[160:163], v[84:87]
    ds_read_b128 v[204:207], v49 offset:3584
    v_mfma_f32_16x16x32_bf16 v[88:91], v[132:135], v[172:175], v[88:91]
    ds_read2_b32 v[224:225], v55 offset0:3 offset1:2
    ds_read2_b32 v[226:227], v55 offset0:1 offset1:0
    v_mfma_f32_16x16x32_bf16 v[88:91], v[140:143], v[164:167], v[88:91]
    ds_read2_b32 v[228:229], v55 offset0:19 offset1:18
    v_mfma_f32_16x16x32_bf16 v[92:95], v[136:139], v[172:175], v[92:95]
    ds_read2_b32 v[230:231], v55 offset0:17 offset1:16
    ds_read2_b32 v[232:233], v55 offset0:35 offset1:34
    v_mfma_f32_16x16x32_bf16 v[92:95], v[140:143], v[168:171], v[92:95]
    ds_read2_b32 v[234:235], v55 offset0:33 offset1:32
    v_mfma_f32_16x16x32_bf16 v[96:99], v[140:143], v[172:175], v[96:99]
    ds_read2_b32 v[236:237], v55 offset0:51 offset1:50
    ds_read2_b32 v[238:239], v55 offset0:49 offset1:48
    v_mfma_f32_16x16x32_bf16 v[88:91], v[144:147], v[160:163], v[88:91]
    ds_read2_b32 v[240:241], v56 offset0:35 offset1:34
    v_mfma_f32_16x16x32_bf16 v[92:95], v[144:147], v[164:167], v[92:95]
    ds_read2_b32 v[242:243], v56 offset0:33 offset1:32
    ds_read2_b32 v[244:245], v56 offset0:51 offset1:50
    v_mfma_f32_16x16x32_bf16 v[96:99], v[144:147], v[168:171], v[96:99]
    ds_read2_b32 v[246:247], v56 offset0:49 offset1:48
    v_mfma_f32_16x16x32_bf16 v[100:103], v[144:147], v[172:175], v[100:103]
    v_cvt_pk_bf16_f32 v16, v104, v108
    v_cvt_pk_bf16_f32 v17, v105, v109
    v_mfma_f32_16x16x32_bf16 v[92:95], v[148:151], v[160:163], v[92:95]
    v_cvt_pk_bf16_f32 v18, v106, v110
    v_mfma_f32_16x16x32_bf16 v[96:99], v[148:151], v[164:167], v[96:99]
    v_cvt_pk_bf16_f32 v19, v107, v111
    v_cvt_pk_bf16_f32 v20, v112, v116
    v_mfma_f32_16x16x32_bf16 v[100:103], v[148:151], v[168:171], v[100:103]
    v_cvt_pk_bf16_f32 v21, v113, v117
    s_waitcnt lgkmcnt(15)
    v_mfma_f32_16x16x32_bf16 v[96:99], v[152:155], v[160:163], v[96:99]
    v_cvt_pk_bf16_f32 v22, v114, v118
    v_cvt_pk_bf16_f32 v23, v115, v119
    v_mfma_f32_16x16x32_bf16 v[100:103], v[152:155], v[164:167], v[100:103]
    v_mfma_f32_16x16x32_bf16 v[100:103], v[156:159], v[160:163], v[100:103]
    s_waitcnt lgkmcnt(10)
    v_mfma_f32_16x16x32_bf16 v[88:91], v[224:227], v[16:19], v[88:91]
    s_mul_i32 s56, s3, 3072
    v_bfe_u32 v24, v0, 1, 5
    s_waitcnt lgkmcnt(8)
    v_mfma_f32_16x16x32_bf16 v[92:95], v[228:231], v[16:19], v[92:95]
    v_mul_u32_u24 v24, 48, v24
    v_and_b32 v3, 1, v0
    s_waitcnt lgkmcnt(6)
    v_mfma_f32_16x16x32_bf16 v[96:99], v[232:235], v[16:19], v[96:99]
    v_lshl_add_u32 v24, v3, 4, v24
    v_add_u32 v24, s56, v24
    s_waitcnt lgkmcnt(4)
    v_mfma_f32_16x16x32_bf16 v[100:103], v[236:239], v[16:19], v[100:103]
    s_lshl_b32 s56, s3, 11
    v_lshlrev_b32 v25, 3, v0
    s_waitcnt lgkmcnt(2)
    v_mfma_f32_16x16x32_bf16 v[96:99], v[240:243], v[20:23], v[96:99]
    v_xor_b32 v26, 1024, v25
    v_lshlrev_b32 v27, 6, v2
    s_waitcnt lgkmcnt(0)
    v_mfma_f32_16x16x32_bf16 v[100:103], v[244:247], v[20:23], v[100:103]
    v_add_u32 v27, v27, v1
    v_mul_u32_u24 v27, 48, v27
    v_mfma_f32_16x16x32_bf16 v[72:75], v[176:179], v[208:211], v[72:75]
    s_mul_i32 s10, s7, 1536
    s_lshl_b32 s11, s6, 4
    v_mfma_f32_16x16x32_bf16 v[76:79], v[176:179], v[212:215], v[76:79]
    s_add_u32 s10, s10, s11
    v_add_u32 v27, s10, v27
    v_mfma_f32_16x16x32_bf16 v[76:79], v[180:183], v[208:211], v[76:79]
    v_and_b32 v28, 1023, v12
    s_mul_i32 s62, s22, 8448
    v_mfma_f32_16x16x32_bf16 v[80:83], v[180:183], v[212:215], v[80:83]
    s_add_u32 s62, s62, s56
    s_add_u32 s62, s62, 4325376
    v_mfma_f32_16x16x32_bf16 v[80:83], v[176:179], v[216:219], v[80:83]
    ds_write_b64 v25, v[74:75] offset:8960
    v_mfma_f32_16x16x32_bf16 v[80:83], v[184:187], v[208:211], v[80:83]
    v_mfma_f32_16x16x32_bf16 v[84:87], v[180:183], v[216:219], v[84:87]
    ds_write_b64 v25, v[78:79] offset:11008
    v_mfma_f32_16x16x32_bf16 v[84:87], v[184:187], v[212:215], v[84:87]
    v_mfma_f32_16x16x32_bf16 v[84:87], v[176:179], v[220:223], v[84:87]
    v_mfma_f32_16x16x32_bf16 v[84:87], v[188:191], v[208:211], v[84:87]
    s_nop 2
    ds_write_b64 v25, v[82:83] offset:13056
    v_mfma_f32_16x16x32_bf16 v[88:91], v[184:187], v[216:219], v[88:91]
    v_mfma_f32_16x16x32_bf16 v[88:91], v[180:183], v[220:223], v[88:91]
    v_mfma_f32_16x16x32_bf16 v[88:91], v[188:191], v[212:215], v[88:91]
    v_mfma_f32_16x16x32_bf16 v[92:95], v[184:187], v[220:223], v[92:95]
    ds_write_b64 v25, v[86:87] offset:15104
    v_mfma_f32_16x16x32_bf16 v[92:95], v[188:191], v[216:219], v[92:95]
    v_mfma_f32_16x16x32_bf16 v[88:91], v[192:195], v[208:211], v[88:91]
    v_mfma_f32_16x16x32_bf16 v[92:95], v[192:195], v[212:215], v[92:95]
    v_mfma_f32_16x16x32_bf16 v[92:95], v[196:199], v[208:211], v[92:95]
    v_mfma_f32_16x16x32_bf16 v[96:99], v[188:191], v[220:223], v[96:99]
    v_mfma_f32_16x16x32_bf16 v[96:99], v[192:195], v[216:219], v[96:99]
    s_nop 3
    ds_write_b64 v25, v[90:91] offset:17152
    v_mfma_f32_16x16x32_bf16 v[100:103], v[192:195], v[220:223], v[100:103]
    v_mfma_f32_16x16x32_bf16 v[96:99], v[196:199], v[212:215], v[96:99]
    ds_write_b64 v25, v[94:95] offset:19200
    v_mfma_f32_16x16x32_bf16 v[100:103], v[196:199], v[216:219], v[100:103]
    v_mfma_f32_16x16x32_bf16 v[96:99], v[200:203], v[208:211], v[96:99]
    v_mfma_f32_16x16x32_bf16 v[100:103], v[200:203], v[212:215], v[100:103]
    v_mfma_f32_16x16x32_bf16 v[100:103], v[204:207], v[208:211], v[100:103]
    s_nop 5
    ds_write_b64 v25, v[98:99] offset:21248
    s_nop 0
    ds_write_b64 v25, v[102:103] offset:23296
    s_setprio 3
    s_waitcnt lgkmcnt(0)
    s_barrier
    ds_read_b64 v[144:145], v26 offset:8960
    ds_read_b64 v[146:147], v26 offset:11008
    ds_read_b64 v[148:149], v26 offset:13056
    ds_read_b64 v[150:151], v26 offset:15104
    ds_read_b64 v[152:153], v26 offset:17152
    ds_read_b64 v[154:155], v26 offset:19200
    ds_read_b64 v[156:157], v26 offset:21248
    ds_read_b64 v[158:159], v26 offset:23296
    s_waitcnt lgkmcnt(7)
    v_add_f32 v144, v144, v72
    v_add_f32 v145, v145, v73
    s_waitcnt lgkmcnt(6)
    v_add_f32 v146, v146, v76
    v_add_f32 v147, v147, v77
    s_waitcnt lgkmcnt(5)
    v_add_f32 v148, v148, v80
    v_add_f32 v149, v149, v81
    s_waitcnt lgkmcnt(4)
    v_add_f32 v150, v150, v84
    v_add_f32 v151, v151, v85
    s_waitcnt lgkmcnt(3)
    v_add_f32 v152, v152, v88
    v_add_f32 v153, v153, v89
    s_waitcnt lgkmcnt(2)
    v_add_f32 v154, v154, v92
    v_add_f32 v155, v155, v93
    s_waitcnt lgkmcnt(1)
    v_add_f32 v156, v156, v96
    v_add_f32 v157, v157, v97
    s_waitcnt lgkmcnt(0)
    v_add_f32 v158, v158, v100
    v_add_f32 v159, v159, v101
    v_cvt_pk_bf16_f32 v224, v144, v146
    v_cvt_pk_bf16_f32 v225, v148, v150
    v_cvt_pk_bf16_f32 v226, v152, v154
    v_cvt_pk_bf16_f32 v227, v156, v158
    ds_write_b128 v27, v[224:227] offset:25344
    v_cvt_pk_bf16_f32 v228, v145, v147
    v_cvt_pk_bf16_f32 v229, v149, v151
    v_cvt_pk_bf16_f32 v230, v153, v155
    v_cvt_pk_bf16_f32 v231, v157, v159
    ds_write_b128 v27, v[228:231] offset:26112
    s_waitcnt lgkmcnt(0)
    s_barrier
    ds_read_b128 v[232:235], v24 offset:25344
    ds_read_b128 v[236:239], v24 offset:26880
    s_waitcnt lgkmcnt(1)
    v_bfi_b32 v232, s5, v68, v232
    v_bfi_b32 v233, s5, v69, v233
    v_bfi_b32 v234, s5, v70, v234
    v_bfi_b32 v235, s5, v71, v235
    buffer_store_dwordx4 v[232:235], v28, s[48:51], s62 offen offset:0 sc1
    s_waitcnt lgkmcnt(0)
    v_bfi_b32 v236, s5, v68, v236
    v_bfi_b32 v237, s5, v69, v237
    v_bfi_b32 v238, s5, v70, v238
    v_bfi_b32 v239, s5, v71, v239
    buffer_store_dwordx4 v[236:239], v28, s[48:51], s62 offen offset:1024 sc1
    s_endpgm
L_exit:
    s_endpgm
L_b2:
    s_mul_i32 s58, s23, 8
    v_mul_u32_u24 v232, 1, v0
    v_add_u32 v232, s58, v232
    v_and_b32 v232, 255, v232
    v_mul_u32_u24 v109, 4112, v232
    v_mov_b32 v10, 0
    v_mov_b32 v11, 0
    s_cmp_eq_u32 s23, 31
    s_cselect_b64 s[10:11], -1, 0
    v_mul_u32_u24 v3, v61, v2
    v_lshlrev_b32 v3, 4, v3
    v_mad_u32_u24 v3, v60, s22, v3
    v_cvt_f32_u32 v9, v3
    v_mul_f32 v9, 0x3a000000, v9
    v_lshrrev_b32 v110, 5, v0
    v_fmamk_f32 v93, v63, 0x3b000000, v9
    v_fmamk_f32 v94, v63, 0x3b800000, v9
    v_fmamk_f32 v95, v63, 0x3bc00000, v9
    v_fmamk_f32 v96, v63, 0x3d000000, v9
    v_fmamk_f32 v97, v63, 0x3d080000, v9
    v_fmamk_f32 v98, v63, 0x3d100000, v9
    v_fmamk_f32 v99, v63, 0x3d180000, v9
    v_fmamk_f32 v100, v63, 0x3d800000, v9
    v_fmamk_f32 v101, v63, 0x3d840000, v9
    v_fmamk_f32 v102, v63, 0x3d880000, v9
    v_fmamk_f32 v103, v63, 0x3d8c0000, v9
    v_fmamk_f32 v104, v63, 0x3dc00000, v9
    v_fmamk_f32 v105, v63, 0x3dc40000, v9
    v_fmamk_f32 v106, v63, 0x3dc80000, v9
    v_fmamk_f32 v107, v63, 0x3dcc0000, v9
    v_mul_u32_u24 v111, 4112, v110
    v_and_b32 v4, 7, v0
    v_cos_f32 v128, v9
    v_sin_f32 v144, v9
    v_cos_f32 v129, v93
    v_sin_f32 v145, v93
    v_cos_f32 v130, v94
    v_sin_f32 v146, v94
    v_cos_f32 v131, v95
    v_sin_f32 v147, v95
    v_cos_f32 v132, v96
    v_sin_f32 v148, v96
    v_cos_f32 v133, v97
    v_sin_f32 v149, v97
    v_cos_f32 v134, v98
    v_sin_f32 v150, v98
    v_cos_f32 v135, v99
    v_sin_f32 v151, v99
    v_cos_f32 v136, v100
    v_sin_f32 v152, v100
    v_cos_f32 v137, v101
    v_sin_f32 v153, v101
    v_cos_f32 v138, v102
    v_sin_f32 v154, v102
    v_cos_f32 v139, v103
    v_sin_f32 v155, v103
    v_cos_f32 v140, v104
    v_sin_f32 v156, v104
    v_cos_f32 v141, v105
    v_sin_f32 v157, v105
    v_cos_f32 v142, v106
    v_sin_f32 v158, v106
    v_cos_f32 v143, v107
    v_sin_f32 v159, v107
    v_lshl_add_u32 v111, v4, 7, v111
    v_lshlrev_b32 v110, 2, v110
    s_mov_b32 exec_lo, 0x1f
    s_mov_b32 exec_hi, 0x1f
    buffer_load_dword v6, v111, s[32:35], s63 offen
    buffer_load_dword v7, v111, s[36:39], s63 offen
    s_mov_b64 exec, -1
    v_mul_u32_u24 v3, v1, v2
    v_cvt_f32_u32 v9, v3
    v_cvt_f32_u32 v108, v1
    v_mul_f32 v9, 0x3d800000, v9
    v_fmamk_f32 v37, v108, 0x3c800000, v9
    v_fmamk_f32 v38, v108, 0x3d000000, v9
    v_fmamk_f32 v39, v108, 0x3d400000, v9
    v_fmamk_f32 v48, v108, 0x3e800000, v9
    v_fmamk_f32 v49, v108, 0x3e880000, v9
    v_fmamk_f32 v50, v108, 0x3e900000, v9
    v_fmamk_f32 v51, v108, 0x3e980000, v9
    v_cmp_eq_u32 vcc, 0, v1
    v_cos_f32 v28, v9
    v_sin_f32 v32, v9
    v_cos_f32 v29, v37
    v_sin_f32 v33, v37
    v_cos_f32 v30, v38
    v_sin_f32 v34, v38
    v_cos_f32 v31, v39
    v_sin_f32 v35, v39
    v_cos_f32 v40, v48
    v_sin_f32 v44, v48
    v_cos_f32 v41, v49
    v_sin_f32 v45, v49
    v_cos_f32 v42, v50
    v_sin_f32 v46, v50
    v_cos_f32 v43, v51
    v_sin_f32 v47, v51
    v_mov_b32 v92, 0xbf803f80
    v_cndmask_b32 v208, 0, v92, vcc
    v_cndmask_b32 v209, 0, v92, vcc
    v_bfe_u32 v93, v0, 2, 3
    v_cmp_eq_u32 vcc, 1, v1
    v_mul_u32_u24 v233, 1056, v93
    v_bfe_u32 v94, v0, 5, 1
    v_cvt_pk_bf16_f32 v160, -v32, -v33
    v_cvt_pk_bf16_f32 v162, v28, v29
    v_cvt_pk_bf16_f32 v164, v32, v33
    v_cvt_pk_bf16_f32 v184, -v32, -v29
    v_cvt_pk_bf16_f32 v186, v28, -v33
    v_cvt_pk_bf16_f32 v188, v32, v29
    v_cvt_pk_bf16_f32 v163, v30, v31
    v_cvt_pk_bf16_f32 v185, v34, v31
    v_cvt_pk_bf16_f32 v189, -v34, -v31
    v_cvt_pk_bf16_f32 v161, -v34, -v35
    v_cvt_pk_bf16_f32 v165, v34, v35
    v_cvt_pk_bf16_f32 v187, -v30, v35
    v_cvt_pk_bf16_f32 v166, -v44, -v45
    v_cvt_pk_bf16_f32 v168, v40, v41
    v_cvt_pk_bf16_f32 v170, v44, v45
    v_cvt_pk_bf16_f32 v190, -v44, -v41
    v_cvt_pk_bf16_f32 v192, v40, -v45
    v_cvt_pk_bf16_f32 v194, v44, v41
    v_cvt_pk_bf16_f32 v169, v42, v43
    v_cvt_pk_bf16_f32 v191, v46, v43
    v_cvt_pk_bf16_f32 v195, -v46, -v43
    v_cvt_pk_bf16_f32 v167, -v46, -v47
    v_cvt_pk_bf16_f32 v171, v46, v47
    v_cvt_pk_bf16_f32 v193, -v42, v47
    v_lshl_add_u32 v233, v94, 8, v233
    v_and_b32 v95, 3, v0
    v_xor_b32 v172, v64, v160
    v_xor_b32 v173, v64, v161
    v_xor_b32 v174, v64, v162
    v_xor_b32 v175, v64, v163
    v_xor_b32 v176, v64, v164
    v_xor_b32 v177, v64, v165
    v_xor_b32 v196, v64, v184
    v_xor_b32 v197, v64, v185
    v_xor_b32 v198, v64, v186
    v_xor_b32 v199, v64, v187
    v_xor_b32 v200, v64, v188
    v_xor_b32 v201, v64, v189
    v_xor_b32 v178, v64, v166
    v_xor_b32 v179, v64, v167
    v_xor_b32 v180, v64, v168
    v_xor_b32 v181, v64, v169
    v_xor_b32 v182, v64, v170
    v_xor_b32 v183, v64, v171
    v_xor_b32 v202, v64, v190
    v_xor_b32 v203, v64, v191
    v_xor_b32 v204, v64, v192
    v_xor_b32 v205, v64, v193
    v_xor_b32 v206, v64, v194
    v_xor_b32 v207, v64, v195
    v_cndmask_b32 v210, 0, v92, vcc
    v_cndmask_b32 v211, 0, v92, vcc
    v_lshl_add_u32 v233, v95, 3, v233
    s_waitcnt vmcnt(2)
    s_setprio 1
    s_barrier
    v_and_b32 v68, 31, v0
    v_lshlrev_b32 v68, 5, v68
    v_mul_u32_u24 v69, 264, v110
    v_add_u32 v69, v69, v68
    ds_read_b128 v[44:47], v69 offset:0
    ds_read_b128 v[52:55], v68 offset:53824
    ds_read_b128 v[56:59], v68 offset:53840
    ds_read_b128 v[48:51], v69 offset:16
    s_waitcnt lgkmcnt(0)
    v_lshlrev_b32 v60, 16, v44
    v_and_b32 v44, 0xffff0000, v44
    v_lshlrev_b32 v62, 16, v45
    v_and_b32 v45, 0xffff0000, v45
    v_lshlrev_b32 v61, 16, v52
    v_and_b32 v52, 0xffff0000, v52
    v_lshlrev_b32 v63, 16, v53
    v_mul_f32 v70, v60, v61
    v_mul_f32 v71, v44, v52
    v_and_b32 v53, 0xffff0000, v53
    v_lshlrev_b32 v64, 16, v46
    v_lshlrev_b32 v65, 16, v54
    v_fmac_f32 v70, v62, v63
    v_fmac_f32 v71, v45, v53
    v_and_b32 v46, 0xffff0000, v46
    v_and_b32 v54, 0xffff0000, v54
    v_lshlrev_b32 v66, 16, v47
    v_lshlrev_b32 v67, 16, v55
    v_fmac_f32 v70, v64, v65
    v_fmac_f32 v71, v46, v54
    v_and_b32 v47, 0xffff0000, v47
    v_and_b32 v55, 0xffff0000, v55
    v_lshlrev_b32 v60, 16, v48
    v_lshlrev_b32 v61, 16, v56
    v_fmac_f32 v70, v66, v67
    v_fmac_f32 v71, v47, v55
    v_and_b32 v48, 0xffff0000, v48
    v_and_b32 v56, 0xffff0000, v56
    v_lshlrev_b32 v62, 16, v49
    v_lshlrev_b32 v63, 16, v57
    v_fmac_f32 v70, v60, v61
    v_fmac_f32 v71, v48, v56
    v_and_b32 v49, 0xffff0000, v49
    v_and_b32 v57, 0xffff0000, v57
    v_lshlrev_b32 v64, 16, v50
    v_lshlrev_b32 v65, 16, v58
    v_fmac_f32 v70, v62, v63
    v_fmac_f32 v71, v49, v57
    v_and_b32 v50, 0xffff0000, v50
    v_and_b32 v58, 0xffff0000, v58
    v_lshlrev_b32 v66, 16, v51
    v_lshlrev_b32 v67, 16, v59
    v_fmac_f32 v70, v64, v65
    v_fmac_f32 v71, v50, v58
    v_and_b32 v51, 0xffff0000, v51
    v_and_b32 v59, 0xffff0000, v59
    v_fmac_f32 v70, v66, v67
    v_fmac_f32 v71, v51, v59
    v_add_f32 v70, v70, v71
    s_nop 1
    v_add_f32_dpp v70, v70, v70 quad_perm:[1,0,3,2] row_mask:0xf bank_mask:0xf
    s_nop 1
    v_add_f32_dpp v70, v70, v70 quad_perm:[2,3,0,1] row_mask:0xf bank_mask:0xf
    s_nop 1
    v_add_f32_dpp v70, v70, v70 row_half_mirror row_mask:0xf bank_mask:0xf
    s_nop 1
    v_add_f32_dpp v70, v70, v70 row_mirror row_mask:0xf bank_mask:0xf
    v_mov_b32 v71, v70
    s_nop 1
    v_permlane16_swap_b32 v70, v71
    v_add_f32 v70, v70, v71
    v_mul_f32 v70, 0xbfb8aa3b, v70
    v_exp_f32 v70, v70
    s_nop 0
    v_add_f32 v70, 1.0, v70
    v_rcp_f32 v70, v70
    s_nop 0
    ds_write_b32 v110, v70 offset:53760
    s_xor_b32 s57, s57, 0xffff
    s_add_u32 s57, s57, 0x9e370000
    ds_read_b64_tr_b16 v[28:29], v233 offset:0
    v_bfe_u32 v24, v0, 2, 3
    ds_read_b64_tr_b16 v[30:31], v233 offset:128
    v_and_b32 v24, 4, v24
    ds_read_b64_tr_b16 v[32:33], v233 offset:512
    v_and_b32 v25, 1, v0
    ds_read_b64_tr_b16 v[34:35], v233 offset:640
    v_lshl_add_u32 v24, v25, 3, v24
    ds_read_b64_tr_b16 v[36:37], v233 offset:32
    v_lshrrev_b32 v20, v24, s57
    ds_read_b64_tr_b16 v[38:39], v233 offset:160
    v_lshlrev_b32 v234, 8, v110
    ds_read_b64_tr_b16 v[40:41], v233 offset:544
    s_mov_b32 s16, 0x10001
    ds_read_b64_tr_b16 v[42:43], v233 offset:672
    v_lshrrev_b32 v21, 1, v20
    ds_read_b64_tr_b16 v[44:45], v233 offset:64
    v_lshrrev_b32 v22, 2, v20
    ds_read_b64_tr_b16 v[46:47], v233 offset:192
    v_lshrrev_b32 v23, 3, v20
    ds_read_b64_tr_b16 v[48:49], v233 offset:576
    v_lshl_add_u32 v234, v1, 5, v234
    ds_read_b64_tr_b16 v[50:51], v233 offset:704
    v_and_b32 v3, 16, v0
    ds_read_b64_tr_b16 v[52:53], v233 offset:96
    v_add_u32 v234, v234, v3
    ds_read_b64_tr_b16 v[54:55], v233 offset:224
    s_mul_i32 s18, s22, 8448
    ds_read_b64_tr_b16 v[56:57], v233 offset:608
    v_lshlrev_b32 v235, 3, v110
    ds_read_b64_tr_b16 v[58:59], v233 offset:736
    v_and_b32 v3, 1, v0
    s_waitcnt lgkmcnt(14)
    v_mfma_f32_16x16x32_bf16 v[60:63], v[28:31], v[112:115], 0
    v_lshl_add_u32 v235, v3, 4, v235
    v_and_b32 v3, 30, v0
    v_mfma_f32_16x16x32_bf16 v[64:67], v[28:31], v[120:123], 0
    s_mul_i32 s17, s22, 8448
    v_lshl_add_u32 v235, v3, 24, v235
    s_waitcnt lgkmcnt(12)
    v_mfma_f32_16x16x32_bf16 v[60:63], v[32:35], v[116:119], v[60:63]
    s_add_u32 s17, s17, 8192
    v_mov_b32 v245, 0
    v_mfma_f32_16x16x32_bf16 v[64:67], v[32:35], v[124:127], v[64:67]
    v_mov_b32 v246, 0
    s_waitcnt lgkmcnt(10)
    v_mfma_f32_16x16x32_bf16 v[68:71], v[36:39], v[112:115], 0
    s_nop 1
    v_mul_f32 v93, v60, v144
    v_mfma_f32_16x16x32_bf16 v[72:75], v[36:39], v[120:123], 0
    v_mul_f32 v95, v61, v145
    v_mul_f32 v92, v64, v144
    s_waitcnt lgkmcnt(8)
    v_mfma_f32_16x16x32_bf16 v[68:71], v[40:43], v[116:119], v[68:71]
    v_mul_f32 v94, v65, v145
    v_mul_f32 v96, v66, v146
    v_mfma_f32_16x16x32_bf16 v[72:75], v[40:43], v[124:127], v[72:75]
    v_mul_f32 v97, v62, v146
    v_mul_f32 v98, v67, v147
    s_waitcnt lgkmcnt(6)
    v_mfma_f32_16x16x32_bf16 v[76:79], v[44:47], v[112:115], 0
    v_mul_f32 v99, v63, v147
    v_fma_f32 v60, v60, v128, v92
    v_mfma_f32_16x16x32_bf16 v[80:83], v[44:47], v[120:123], 0
    v_fma_f32 v64, v64, v128, -v93
    v_fma_f32 v61, v61, v129, v94
    s_waitcnt lgkmcnt(4)
    v_mfma_f32_16x16x32_bf16 v[76:79], v[48:51], v[116:119], v[76:79]
    v_fma_f32 v65, v65, v129, -v95
    v_fma_f32 v62, v62, v130, v96
    v_mfma_f32_16x16x32_bf16 v[80:83], v[48:51], v[124:127], v[80:83]
    v_fma_f32 v66, v66, v130, -v97
    v_fma_f32 v63, v63, v131, v98
    s_waitcnt lgkmcnt(2)
    v_mfma_f32_16x16x32_bf16 v[84:87], v[52:55], v[112:115], 0
    v_fma_f32 v67, v67, v131, -v99
    v_cvt_pk_bf16_f32 v28, v60, v61
    v_mfma_f32_16x16x32_bf16 v[88:91], v[52:55], v[120:123], 0
    v_cvt_pk_bf16_f32 v30, v64, v65
    v_cvt_pk_bf16_f32 v29, v62, v63
    v_cvt_pk_bf16_f32 v31, v66, v67
    s_waitcnt lgkmcnt(0)
    v_mfma_f32_16x16x32_bf16 v[84:87], v[56:59], v[116:119], v[84:87]
    v_mul_f32 v100, v72, v148
    v_mul_f32 v101, v68, v148
    v_mfma_f32_16x16x32_bf16 v[88:91], v[56:59], v[124:127], v[88:91]
    v_mul_f32 v102, v73, v149
    v_mul_f32 v103, v69, v149
    v_mul_f32 v104, v74, v150
    v_mul_f32 v105, v70, v150
    v_mul_f32 v106, v75, v151
    v_mul_f32 v107, v71, v151
    v_mfma_f32_16x16x32_bf16 v[212:215], v[28:31], v[162:165], 0
    v_fma_f32 v68, v68, v132, v100
    v_fma_f32 v72, v72, v132, -v101
    v_mfma_f32_16x16x32_bf16 v[216:219], v[28:31], v[160:163], 0
    v_fma_f32 v69, v69, v133, v102
    v_fma_f32 v73, v73, v133, -v103
    v_fma_f32 v70, v70, v134, v104
    v_fma_f32 v74, v74, v134, -v105
    v_fma_f32 v71, v71, v135, v106
    v_fma_f32 v75, v75, v135, -v107
    v_mfma_f32_16x16x32_bf16 v[220:223], v[28:31], v[186:189], 0
    v_cvt_pk_bf16_f32 v36, v68, v69
    v_cvt_pk_bf16_f32 v38, v72, v73
    v_mfma_f32_16x16x32_bf16 v[224:227], v[28:31], v[184:187], 0
    v_cvt_pk_bf16_f32 v37, v70, v71
    v_cvt_pk_bf16_f32 v39, v74, v75
    v_mul_f32 v92, v80, v152
    v_mul_f32 v93, v76, v152
    v_mul_f32 v94, v81, v153
    v_mul_f32 v95, v77, v153
    v_mul_f32 v96, v82, v154
    v_mul_f32 v97, v78, v154
    v_mul_f32 v98, v83, v155
    v_mul_f32 v99, v79, v155
    v_mfma_f32_16x16x32_bf16 v[212:215], v[36:39], v[168:171], v[212:215]
    v_fma_f32 v76, v76, v136, v92
    v_fma_f32 v80, v80, v136, -v93
    v_mfma_f32_16x16x32_bf16 v[216:219], v[36:39], v[166:169], v[216:219]
    v_fma_f32 v77, v77, v137, v94
    v_fma_f32 v81, v81, v137, -v95
    v_fma_f32 v78, v78, v138, v96
    v_fma_f32 v82, v82, v138, -v97
    v_fma_f32 v79, v79, v139, v98
    v_fma_f32 v83, v83, v139, -v99
    v_mfma_f32_16x16x32_bf16 v[220:223], v[36:39], v[192:195], v[220:223]
    v_cvt_pk_bf16_f32 v44, v76, v77
    v_cvt_pk_bf16_f32 v46, v80, v81
    v_mfma_f32_16x16x32_bf16 v[224:227], v[36:39], v[190:193], v[224:227]
    v_cvt_pk_bf16_f32 v45, v78, v79
    v_cvt_pk_bf16_f32 v47, v82, v83
    v_mul_f32 v100, v88, v156
    v_mul_f32 v101, v84, v156
    v_mul_f32 v102, v89, v157
    v_mul_f32 v103, v85, v157
    v_mul_f32 v104, v90, v158
    v_mul_f32 v105, v86, v158
    v_mul_f32 v106, v91, v159
    v_mul_f32 v107, v87, v159
    v_mfma_f32_16x16x32_bf16 v[212:215], v[44:47], v[174:177], v[212:215]
    v_fma_f32 v84, v84, v140, v100
    v_fma_f32 v88, v88, v140, -v101
    v_mfma_f32_16x16x32_bf16 v[216:219], v[44:47], v[172:175], v[216:219]
    v_fma_f32 v85, v85, v141, v102
    v_fma_f32 v89, v89, v141, -v103
    v_fma_f32 v86, v86, v142, v104
    v_fma_f32 v90, v90, v142, -v105
    v_fma_f32 v87, v87, v143, v106
    v_fma_f32 v91, v91, v143, -v107
    v_mfma_f32_16x16x32_bf16 v[220:223], v[44:47], v[198:201], v[220:223]
    v_cvt_pk_bf16_f32 v52, v84, v85
    v_cvt_pk_bf16_f32 v54, v88, v89
    v_mfma_f32_16x16x32_bf16 v[224:227], v[44:47], v[196:199], v[224:227]
    v_cvt_pk_bf16_f32 v53, v86, v87
    v_cvt_pk_bf16_f32 v55, v90, v91
    v_mfma_f32_16x16x32_bf16 v[228:231], v[28:31], v[208:211], 0
    s_nop 0
    v_mfma_f32_16x16x32_bf16 v[212:215], v[52:55], v[180:183], v[212:215]
    v_mfma_f32_16x16x32_bf16 v[216:219], v[52:55], v[178:181], v[216:219]
    v_mfma_f32_16x16x32_bf16 v[220:223], v[52:55], v[204:207], v[220:223]
    v_mfma_f32_16x16x32_bf16 v[224:227], v[52:55], v[202:205], v[224:227]
    s_nop 5
    v_cvt_pk_bf16_f32 v32, v212, v216
    v_cvt_pk_bf16_f32 v33, v213, v217
    v_cvt_pk_bf16_f32 v34, v214, v218
    v_cvt_pk_bf16_f32 v35, v215, v219
    v_bfi_b32 v32, s16, v20, v32
    v_bfi_b32 v33, s16, v21, v33
    v_bfi_b32 v34, s16, v22, v34
    v_bfi_b32 v35, s16, v23, v35
    v_cvt_pk_bf16_f32 v40, v220, v224
    v_cvt_pk_bf16_f32 v41, v221, v225
    v_cvt_pk_bf16_f32 v42, v222, v226
    v_cvt_pk_bf16_f32 v43, v223, v227
    buffer_store_dwordx4 v[32:35], v234, s[44:47], s18 offen offset:0 sc1
    v_bfi_b32 v40, s16, v20, v40
    v_bfi_b32 v41, s16, v21, v41
    v_bfi_b32 v42, s16, v22, v42
    v_bfi_b32 v43, s16, v23, v43
    buffer_store_dwordx4 v[40:43], v234, s[44:47], s18 offen offset:512 sc1
    v_mfma_f32_16x16x32_bf16 v[228:231], v[36:39], v[208:211], v[228:231]
    v_mfma_f32_16x16x32_bf16 v[228:231], v[44:47], v[208:211], v[228:231]
    v_mfma_f32_16x16x32_bf16 v[228:231], v[52:55], v[208:211], v[228:231]
    s_nop 7
    v_mov_b32_dpp v92, v228 quad_perm:[1,1,1,1] row_mask:0xf bank_mask:0xf
    v_cvt_pk_bf16_f32 v244, v228, v92
    v_add_u32 v247, s57, v244
    buffer_store_dwordx4 v[244:247], v235, s[44:47], s17 offen sc1
    s_mov_b32 s16, 0x10001
    s_lshl_b32 s56, s3, 3
    s_lshl_b32 s52, s27, 5
    s_add_u32 s52, s52, 8192
    s_add_u32 s53, s52, 135168
    s_add_u32 s54, s52, 270336
    s_add_u32 s55, s52, 405504
    s_lshl_b32 s19, s23, 2
    s_add_u32 s19, s19, s3
    v_bfe_u32 v111, v0, 1, 5
    s_lshl_b32 s58, s3, 4
    v_mul_f32 v9, 0x3e800000, v9
    v_and_b32 v4, 3, v0
    v_mul_u32_u24 v111, 48, v111
    v_and_b32 v3, 1, v0
    s_lshr_b32 s24, s22, 1
    v_fmamk_f32 v98, v108, 0x3b800000, v9
    v_fmamk_f32 v102, v108, 0x3c000000, v9
    v_fmamk_f32 v106, v108, 0x3c400000, v9
    v_lshlrev_b32 v4, 2, v4
    v_lshl_add_u32 v111, v3, 4, v111
    s_lshl_b32 s24, s24, 6
    v_mul_f32 v95, 0x41800000, v9
    v_mul_f32 v99, 0x41800000, v98
    v_mul_f32 v103, 0x41800000, v102
    v_mul_f32 v107, 0x41800000, v106
    v_lshrrev_b32 v236, v4, s57
    v_lshlrev_b32 v3, 6, v2
    s_mul_i32 s48, s3, 540672
    v_cos_f32 v92, v95
    v_sin_f32 v93, v95
    v_cos_f32 v96, v99
    v_sin_f32 v97, v99
    v_cos_f32 v100, v103
    v_sin_f32 v101, v103
    v_cos_f32 v104, v107
    v_sin_f32 v105, v107
    v_and_b32 v248, 3, v0
    v_bfe_u32 v4, v0, 2, 4
    v_add_u32 v3, v3, v1
    s_add_u32 s48, s48, s24
    v_lshlrev_b32 v248, 4, v248
    v_mul_u32_u24 v233, 8448, v4
    v_mul_u32_u24 v240, 48, v4
    v_mul_u32_u24 v235, 48, v3
    s_add_u32 s49, s48, 135168
    v_lshrrev_b32 v237, 1, v236
    v_lshrrev_b32 v238, 2, v236
    v_lshrrev_b32 v239, 3, v236
    v_and_b32 v4, 16, v248
    v_mul_u32_u24 v241, 80, v3
    v_add_u32 v234, s56, v235
    s_add_u32 s50, s48, 270336
    v_cos_f32 v20, v9
    v_sin_f32 v24, v9
    v_cos_f32 v21, v98
    v_sin_f32 v25, v98
    v_cos_f32 v22, v102
    v_sin_f32 v26, v102
    v_cos_f32 v23, v106
    v_sin_f32 v27, v106
    v_cvt_pk_bf16_f32 v200, v92, v93
    v_cvt_pk_bf16_f32 v204, -v93, v92
    v_cvt_pk_bf16_f32 v201, v96, v97
    v_cvt_pk_bf16_f32 v205, -v97, v96
    v_cvt_pk_bf16_f32 v202, v100, v101
    v_cvt_pk_bf16_f32 v206, -v101, v100
    v_cvt_pk_bf16_f32 v203, v104, v105
    v_cvt_pk_bf16_f32 v207, -v105, v104
    v_and_b32 v236, 0x10001, v236
    v_and_b32 v237, 0x10001, v237
    v_and_b32 v238, 0x10001, v238
    v_and_b32 v239, 0x10001, v239
    v_add_u32 v111, s7, v111
    v_add_u32 v233, v233, v248
    v_add3_u32 v240, v240, v4, s7
    v_mul_u32_u24 v235, 8448, v3
    v_add_u32 v243, s58, v241
    s_add_u32 s51, s48, 405504
    s_cmp_eq_u32 s23, 31
    s_cselect_b64 s[10:11], -1, 1
    v_mov_b32 v10, 0
    buffer_load_dwordx4 v[12:15], v109, s[32:35], s62 offen
    s_mov_b64 exec, s[10:11]
    buffer_load_short_d16_hi v10, v109, s[32:35], s62 offen offset:16
    s_mov_b64 exec, -1
    v_mov_b32 v11, 0
    buffer_load_dwordx4 v[16:19], v109, s[36:39], s62 offen
    s_mov_b64 exec, s[10:11]
    buffer_load_short_d16_hi v11, v109, s[36:39], s62 offen offset:16
    s_mov_b64 exec, -1
    buffer_load_dwordx4 v[28:31], v233, s[44:47], s48 offen sc1
    buffer_load_dwordx4 v[32:35], v233, s[44:47], s49 offen sc1
    buffer_load_dwordx4 v[36:39], v233, s[44:47], s50 offen sc1
    buffer_load_dwordx4 v[40:43], v233, s[44:47], s51 offen sc1
    s_setprio 3
    s_waitcnt vmcnt(4)
    s_cmp_eq_u32 s23, 0
    v_lshlrev_b32 v76, 16, v12
    v_lshlrev_b32 v77, 16, v16
    s_cselect_b32 s56, 0.5, 1.0
    v_and_b32 v78, 0xffff0000, v12
    v_and_b32 v79, 0xffff0000, v16
    v_mul_f32 v76, s56, v76
    v_mul_f32 v77, s56, v77
    v_mul_u32_u24 v4, 80, v232
    v_lshlrev_b32 v80, 16, v13
    v_lshlrev_b32 v81, 16, v17
    v_and_b32 v82, 0xffff0000, v13
    v_and_b32 v83, 0xffff0000, v17
    ds_write_b128 v4, v[76:79] offset:33280
    v_lshlrev_b32 v84, 16, v14
    v_lshlrev_b32 v85, 16, v18
    v_and_b32 v86, 0xffff0000, v14
    v_and_b32 v87, 0xffff0000, v18
    ds_write_b128 v4, v[80:83] offset:33296
    v_lshlrev_b32 v88, 16, v15
    v_lshlrev_b32 v89, 16, v19
    v_and_b32 v90, 0xffff0000, v15
    v_and_b32 v91, 0xffff0000, v19
    ds_write_b128 v4, v[84:87] offset:33312
    v_mul_f32 v10, 0.5, v10
    v_mul_f32 v11, 0.5, v11
    ds_write_b128 v4, v[88:91] offset:33328
    ds_write_b64 v4, v[10:11] offset:33344
    s_bitcmp1_b32 s22, 0
    s_mov_b32 s10, 0x33333333
    s_cselect_b32 s10, 0xcccccccc, s10
    s_mov_b32 s11, s10
    s_setprio 3
    s_mov_b32 s59, 30000
L_tag2:
    s_waitcnt vmcnt(3)
    v_xor_b32 v28, v236, v28
    v_xor_b32 v29, v237, v29
    v_xor_b32 v30, v238, v30
    v_xor_b32 v31, v239, v31
    v_or3_b32 v6, v28, v29, v30
    v_or_b32 v6, v6, v31
    s_waitcnt vmcnt(2)
    v_xor_b32 v32, v236, v32
    v_xor_b32 v33, v237, v33
    v_xor_b32 v34, v238, v34
    v_xor_b32 v35, v239, v35
    v_or3_b32 v6, v6, v32, v33
    v_or3_b32 v6, v6, v34, v35
    s_waitcnt vmcnt(1)
    v_xor_b32 v36, v236, v36
    v_xor_b32 v37, v237, v37
    v_xor_b32 v38, v238, v38
    v_xor_b32 v39, v239, v39
    v_or3_b32 v6, v6, v36, v37
    v_or3_b32 v6, v6, v38, v39
    s_waitcnt vmcnt(0)
    v_xor_b32 v40, v236, v40
    v_xor_b32 v41, v237, v41
    v_xor_b32 v42, v238, v42
    v_xor_b32 v43, v239, v43
    v_or3_b32 v6, v6, v40, v41
    v_or3_b32 v6, v6, v42, v43
    v_and_b32 v6, 0x10001, v6
    v_cmp_ne_u32 vcc, 0, v6
    s_cbranch_vccz L_tag2_out
    s_sub_u32 s59, s59, 1
    s_cbranch_scc1 L_tag2_out
    s_wqm_b64 exec, vcc
    s_sleep 4
    buffer_load_dwordx4 v[28:31], v233, s[44:47], s48 offen sc1
    buffer_load_dwordx4 v[32:35], v233, s[44:47], s49 offen sc1
    buffer_load_dwordx4 v[36:39], v233, s[44:47], s50 offen sc1
    buffer_load_dwordx4 v[40:43], v233, s[44:47], s51 offen sc1
    s_branch L_tag2
L_tag2_out:
    s_mov_b64 exec, -1
    s_mov_b64 exec, s[10:11]
    ds_write_b128 v240, v[28:31] offset:20992
    ds_write_b128 v240, v[32:35] offset:21760
    ds_write_b128 v240, v[36:39] offset:22528
    ds_write_b128 v240, v[40:43] offset:23296
    s_mov_b64 exec, -1
    s_waitcnt lgkmcnt(0)
    s_barrier
    s_cmp_lg_u32 s19, 127
    s_cbranch_scc1 L_b_nn1
    buffer_load_dwordx4 v[216:219], v235, s[44:47], s52 offen sc1
    buffer_load_dwordx4 v[220:223], v235, s[44:47], s53 offen sc1
    buffer_load_dwordx4 v[224:227], v235, s[44:47], s54 offen sc1
    buffer_load_dwordx4 v[228:231], v235, s[44:47], s55 offen sc1
L_b_nn1:
    ds_read_b64 v[36:37], v234 offset:20992
    ds_read_b64 v[40:41], v234 offset:21760
    ds_read_b64 v[38:39], v234 offset:22528
    ds_read_b64 v[42:43], v234 offset:23296
    ds_read_b128 v[160:163], v243 offset:33280
    ds_read_b128 v[164:167], v243 offset:34560
    ds_read_b128 v[168:171], v243 offset:35840
    ds_read_b128 v[172:175], v243 offset:37120
    s_waitcnt lgkmcnt(6)
    v_swap_b32 v37, v40
    s_waitcnt lgkmcnt(4)
    v_swap_b32 v39, v42
    s_nop 1
    v_mfma_f32_16x16x32_bf16 v[60:63], v[36:39], v[200:203], 0
    v_mfma_f32_16x16x32_bf16 v[64:67], v[36:39], v[204:207], 0
    v_mfma_f32_16x16x32_bf16 v[68:71], v[40:43], v[200:203], 0
    s_nop 5
    v_mul_f32 v93, v60, v24
    v_mfma_f32_16x16x32_bf16 v[72:75], v[40:43], v[204:207], 0
    v_mul_f32 v95, v61, v25
    v_mul_f32 v92, v64, v24
    v_mul_f32 v94, v65, v25
    v_mul_f32 v96, v66, v26
    v_mul_f32 v97, v62, v26
    v_mul_f32 v98, v67, v27
    v_mul_f32 v99, v63, v27
    v_fma_f32 v60, v60, v20, v92
    v_fma_f32 v64, v64, v20, -v93
    v_fma_f32 v61, v61, v21, v94
    v_fma_f32 v65, v65, v21, -v95
    v_fma_f32 v62, v62, v22, v96
    v_fma_f32 v66, v66, v22, -v97
    v_fma_f32 v63, v63, v23, v98
    v_fma_f32 v67, v67, v23, -v99
    v_cvt_pk_bf16_f32 v36, v60, v64
    v_cvt_pk_bf16_f32 v37, v61, v65
    v_cvt_pk_bf16_f32 v38, v62, v66
    v_cvt_pk_bf16_f32 v39, v63, v67
    v_mul_f32 v184, v72, v24
    v_mul_f32 v185, v68, v24
    v_mul_f32 v186, v73, v25
    v_mul_f32 v187, v69, v25
    v_mul_f32 v188, v74, v26
    v_mul_f32 v189, v70, v26
    v_mul_f32 v190, v75, v27
    v_mul_f32 v191, v71, v27
    v_mfma_f32_16x16x32_bf16 v[60:63], v[200:203], v[36:39], 0
    v_fma_f32 v68, v68, v20, v184
    v_fma_f32 v72, v72, v20, -v185
    v_mfma_f32_16x16x32_bf16 v[64:67], v[204:207], v[36:39], 0
    v_fma_f32 v69, v69, v21, v186
    v_fma_f32 v73, v73, v21, -v187
    v_fma_f32 v70, v70, v22, v188
    v_fma_f32 v74, v74, v22, -v189
    v_fma_f32 v71, v71, v23, v190
    v_fma_f32 v75, v75, v23, -v191
    v_cvt_pk_bf16_f32 v40, v68, v72
    v_cvt_pk_bf16_f32 v41, v69, v73
    v_cvt_pk_bf16_f32 v42, v70, v74
    v_cvt_pk_bf16_f32 v43, v71, v75
    s_waitcnt lgkmcnt(3)
    v_mul_f32 v92, v64, v161
    v_mul_f32 v93, v60, v161
    v_mfma_f32_16x16x32_bf16 v[68:71], v[200:203], v[40:43], 0
    s_waitcnt lgkmcnt(2)
    v_mul_f32 v94, v65, v165
    v_mul_f32 v95, v61, v165
    v_mfma_f32_16x16x32_bf16 v[72:75], v[204:207], v[40:43], 0
    s_waitcnt lgkmcnt(1)
    v_mul_f32 v96, v66, v169
    v_mul_f32 v97, v62, v169
    s_waitcnt lgkmcnt(0)
    v_mul_f32 v98, v67, v173
    v_mul_f32 v99, v63, v173
    v_fma_f32 v60, v60, v160, -v92
    v_fma_f32 v64, v64, v160, v93
    v_fma_f32 v61, v61, v164, -v94
    v_fma_f32 v65, v65, v164, v95
    v_fma_f32 v62, v62, v168, -v96
    v_fma_f32 v66, v66, v168, v97
    v_fma_f32 v63, v63, v172, -v98
    v_fma_f32 v67, v67, v172, v99
    v_cvt_pk_bf16_f32 v36, v64, v60
    v_cvt_pk_bf16_f32 v37, v65, v61
    v_cvt_pk_bf16_f32 v38, v66, v62
    v_cvt_pk_bf16_f32 v39, v67, v63
    v_mul_f32 v184, v72, v163
    v_mul_f32 v185, v68, v163
    v_mul_f32 v186, v73, v167
    v_mul_f32 v187, v69, v167
    v_mul_f32 v188, v74, v171
    v_mul_f32 v189, v70, v171
    v_mul_f32 v190, v75, v175
    v_mul_f32 v191, v71, v175
    v_mfma_f32_16x16x32_bf16 v[64:67], v[36:39], v[200:203], 0
    v_fma_f32 v68, v68, v162, -v184
    v_fma_f32 v72, v72, v162, v185
    v_mfma_f32_16x16x32_bf16 v[60:63], v[36:39], v[204:207], 0
    v_fma_f32 v69, v69, v166, -v186
    v_fma_f32 v73, v73, v166, v187
    v_fma_f32 v70, v70, v170, -v188
    v_fma_f32 v74, v74, v170, v189
    v_fma_f32 v71, v71, v174, -v190
    v_fma_f32 v75, v75, v174, v191
    v_cvt_pk_bf16_f32 v40, v72, v68
    v_cvt_pk_bf16_f32 v41, v73, v69
    v_cvt_pk_bf16_f32 v42, v74, v70
    v_cvt_pk_bf16_f32 v43, v75, v71
    v_mul_f32 v92, v64, v24
    v_mul_f32 v93, v60, v24
    v_mfma_f32_16x16x32_bf16 v[72:75], v[40:43], v[200:203], 0
    v_mul_f32 v94, v65, v25
    v_mul_f32 v95, v61, v25
    v_mfma_f32_16x16x32_bf16 v[68:71], v[40:43], v[204:207], 0
    v_mul_f32 v96, v66, v26
    v_mul_f32 v97, v62, v26
    v_mul_f32 v98, v67, v27
    v_mul_f32 v99, v63, v27
    v_fma_f32 v60, v60, v20, -v92
    v_fma_f32 v64, v64, v20, v93
    v_fma_f32 v61, v61, v21, -v94
    v_fma_f32 v65, v65, v21, v95
    v_fma_f32 v62, v62, v22, -v96
    v_fma_f32 v66, v66, v22, v97
    v_fma_f32 v63, v63, v23, -v98
    v_fma_f32 v67, v67, v23, v99
    v_cvt_pk_bf16_f32 v36, v64, v60
    v_cvt_pk_bf16_f32 v37, v65, v61
    v_cvt_pk_bf16_f32 v38, v66, v62
    v_cvt_pk_bf16_f32 v39, v67, v63
    v_mul_f32 v184, v72, v24
    v_mul_f32 v185, v68, v24
    v_mul_f32 v186, v73, v25
    v_mul_f32 v187, v69, v25
    v_mul_f32 v188, v74, v26
    v_mul_f32 v189, v70, v26
    v_mul_f32 v190, v75, v27
    v_mul_f32 v191, v71, v27
    v_mfma_f32_16x16x32_bf16 v[64:67], v[200:203], v[36:39], 0
    v_fma_f32 v68, v68, v20, -v184
    v_fma_f32 v72, v72, v20, v185
    v_mfma_f32_16x16x32_bf16 v[60:63], v[204:207], v[36:39], 0
    v_fma_f32 v69, v69, v21, -v186
    v_fma_f32 v73, v73, v21, v187
    v_fma_f32 v70, v70, v22, -v188
    v_fma_f32 v74, v74, v22, v189
    v_fma_f32 v71, v71, v23, -v190
    v_fma_f32 v75, v75, v23, v191
    v_cvt_pk_bf16_f32 v40, v72, v68
    v_cvt_pk_bf16_f32 v41, v73, v69
    v_cvt_pk_bf16_f32 v42, v74, v70
    v_cvt_pk_bf16_f32 v43, v75, v71
    v_cvt_pk_bf16_f32 v28, v60, v64
    v_cvt_pk_bf16_f32 v30, v61, v65
    v_mfma_f32_16x16x32_bf16 v[72:75], v[200:203], v[40:43], 0
    v_cvt_pk_bf16_f32 v32, v62, v66
    v_cvt_pk_bf16_f32 v34, v63, v67
    v_mfma_f32_16x16x32_bf16 v[68:71], v[204:207], v[40:43], 0
    s_nop 7
    v_cvt_pk_bf16_f32 v29, v68, v72
    ds_write_b64 v234, v[28:29] offset:8704
    v_cvt_pk_bf16_f32 v31, v69, v73
    ds_write_b64 v234, v[30:31] offset:9472
    v_cvt_pk_bf16_f32 v33, v70, v74
    ds_write_b64 v234, v[32:33] offset:10240
    v_cvt_pk_bf16_f32 v35, v71, v75
    ds_write_b64 v234, v[34:35] offset:11008
    s_waitcnt lgkmcnt(0)
    s_barrier
    ds_read_b128 v[48:51], v111 offset:8704
    ds_read_b128 v[52:55], v111 offset:10240
    s_waitcnt lgkmcnt(1)
    v_bfi_b32 v48, s16, v236, v48
    v_bfi_b32 v49, s16, v237, v49
    v_bfi_b32 v50, s16, v238, v50
    v_bfi_b32 v51, s16, v239, v51
    buffer_store_dwordx4 v[48:51], v5, s[44:47], s8 offen offset:0 sc1
    s_waitcnt lgkmcnt(0)
    v_bfi_b32 v52, s16, v236, v52
    v_bfi_b32 v53, s16, v237, v53
    v_bfi_b32 v54, s16, v238, v54
    v_bfi_b32 v55, s16, v239, v55
    buffer_store_dwordx4 v[52:55], v5, s[44:47], s8 offen offset:1024 sc1
    s_cmp_lg_u32 s19, 127
    s_cbranch_scc1 L_b_nonyq
    s_mov_b32 s59, 30000
L_poll3:
    s_waitcnt vmcnt(5)
    v_add3_u32 v7, v216, v217, v218
    v_sub_u32 v7, v219, v7
    v_xor_b32 v6, s57, v7
    s_waitcnt vmcnt(4)
    v_add3_u32 v7, v220, v221, v222
    v_sub_u32 v7, v223, v7
    v_xor_b32 v7, s57, v7
    v_or_b32 v6, v6, v7
    s_waitcnt vmcnt(3)
    v_add3_u32 v7, v224, v225, v226
    v_sub_u32 v7, v227, v7
    v_xor_b32 v7, s57, v7
    v_or_b32 v6, v6, v7
    s_waitcnt vmcnt(2)
    v_add3_u32 v7, v228, v229, v230
    v_sub_u32 v7, v231, v7
    v_xor_b32 v7, s57, v7
    v_or_b32 v6, v6, v7
    v_cmp_ne_u32 vcc, 0, v6
    s_cbranch_vccz L_poll3_out
    s_sub_u32 s59, s59, 1
    s_cbranch_scc1 L_poll3_out
    s_mov_b64 exec, vcc
    s_sleep 4
    buffer_load_dwordx4 v[216:219], v235, s[44:47], s52 offen sc1
    buffer_load_dwordx4 v[220:223], v235, s[44:47], s53 offen sc1
    buffer_load_dwordx4 v[224:227], v235, s[44:47], s54 offen sc1
    buffer_load_dwordx4 v[228:231], v235, s[44:47], s55 offen sc1
    s_waitcnt vmcnt(0)
    s_branch L_poll3
L_poll3_out:
    s_mov_b64 exec, -1
    v_mov_b32 v44, v216
    v_mov_b32 v45, v220
    v_mov_b32 v46, v224
    v_mov_b32 v47, v228
    ds_read_b64 v[176:177], v241 offset:33344
    v_lshlrev_b32 v3, 10, v2
    ds_read_b64 v[178:179], v241 offset:34624
    v_mfma_f32_16x16x32_bf16 v[76:79], v[44:47], v[200:203], 0
    ds_read_b64 v[180:181], v241 offset:35904
    s_lshl_b32 s56, s27, 12
    v_mfma_f32_16x16x32_bf16 v[80:83], v[44:47], v[204:207], 0
    ds_read_b64 v[182:183], v241 offset:37184
    v_lshl_add_u32 v3, v1, 4, v3
    s_add_u32 s56, s56, 12910592
    v_mov_b32 v61, 0
    v_mov_b32 v62, 0
    v_mul_f32 v193, v76, v24
    v_mul_f32 v195, v77, v25
    v_mul_f32 v197, v78, v26
    v_mul_f32 v199, v79, v27
    v_mul_f32 v192, v80, v24
    v_mul_f32 v194, v81, v25
    v_mul_f32 v196, v82, v26
    v_mul_f32 v198, v83, v27
    v_fma_f32 v76, v76, v20, v192
    v_fma_f32 v80, v80, v20, -v193
    v_fma_f32 v77, v77, v21, v194
    v_fma_f32 v81, v81, v21, -v195
    v_fma_f32 v78, v78, v22, v196
    v_fma_f32 v82, v82, v22, -v197
    v_fma_f32 v79, v79, v23, v198
    v_fma_f32 v83, v83, v23, -v199
    v_cvt_pk_bf16_f32 v44, v76, v80
    v_cvt_pk_bf16_f32 v45, v77, v81
    v_cvt_pk_bf16_f32 v46, v78, v82
    v_cvt_pk_bf16_f32 v47, v79, v83
    v_mov_b32 v65, 0
    v_mov_b32 v66, 0
    v_mfma_f32_16x16x32_bf16 v[76:79], v[200:203], v[44:47], 0
    v_mov_b32 v69, 0
    v_mov_b32 v70, 0
    v_mfma_f32_16x16x32_bf16 v[80:83], v[204:207], v[44:47], 0
    v_mov_b32 v73, 0
    v_mov_b32 v74, 0
    s_waitcnt lgkmcnt(3)
    s_nop 1
    v_mul_f32 v193, v76, v177
    s_waitcnt lgkmcnt(2)
    v_mul_f32 v195, v77, v179
    s_waitcnt lgkmcnt(1)
    v_mul_f32 v197, v78, v181
    s_waitcnt lgkmcnt(0)
    v_mul_f32 v199, v79, v183
    v_mul_f32 v192, v80, v177
    v_mul_f32 v194, v81, v179
    v_mul_f32 v196, v82, v181
    v_mul_f32 v198, v83, v183
    v_fma_f32 v76, v76, v176, -v192
    v_fma_f32 v80, v80, v176, v193
    v_fma_f32 v77, v77, v178, -v194
    v_fma_f32 v81, v81, v178, v195
    v_fma_f32 v78, v78, v180, -v196
    v_fma_f32 v82, v82, v180, v197
    v_fma_f32 v79, v79, v182, -v198
    v_fma_f32 v83, v83, v182, v199
    v_cvt_pk_bf16_f32 v44, v80, v76
    v_cvt_pk_bf16_f32 v45, v81, v77
    v_cvt_pk_bf16_f32 v46, v82, v78
    v_cvt_pk_bf16_f32 v47, v83, v79
    s_nop 1
    v_mfma_f32_16x16x32_bf16 v[80:83], v[44:47], v[200:203], 0
    v_mfma_f32_16x16x32_bf16 v[76:79], v[44:47], v[204:207], 0
    s_nop 6
    v_mul_f32 v192, v80, v24
    v_mul_f32 v194, v81, v25
    v_mul_f32 v196, v82, v26
    v_mul_f32 v198, v83, v27
    v_mul_f32 v193, v76, v24
    v_mul_f32 v195, v77, v25
    v_mul_f32 v197, v78, v26
    v_mul_f32 v199, v79, v27
    v_fma_f32 v76, v76, v20, -v192
    v_fma_f32 v80, v80, v20, v193
    v_fma_f32 v77, v77, v21, -v194
    v_fma_f32 v81, v81, v21, v195
    v_fma_f32 v78, v78, v22, -v196
    v_fma_f32 v82, v82, v22, v197
    v_fma_f32 v79, v79, v23, -v198
    v_fma_f32 v83, v83, v23, v199
    v_cvt_pk_bf16_f32 v44, v80, v76
    v_cvt_pk_bf16_f32 v45, v81, v77
    v_cvt_pk_bf16_f32 v46, v82, v78
    v_cvt_pk_bf16_f32 v47, v83, v79
    s_nop 1
    v_mfma_f32_16x16x32_bf16 v[80:83], v[200:203], v[44:47], 0
    v_mfma_f32_16x16x32_bf16 v[76:79], v[204:207], v[44:47], 0
    s_nop 7
    v_cvt_pk_bf16_f32 v60, v76, v80
    v_add_u32 v63, s57, v60
    v_cvt_pk_bf16_f32 v64, v77, v81
    buffer_store_dwordx4 v[60:63], v3, s[44:47], s56 offen offset:0 sc1
    v_add_u32 v67, s57, v64
    v_cvt_pk_bf16_f32 v68, v78, v82
    buffer_store_dwordx4 v[64:67], v3, s[44:47], s56 offen offset:256 sc1
    v_add_u32 v71, s57, v68
    v_cvt_pk_bf16_f32 v72, v79, v83
    buffer_store_dwordx4 v[68:71], v3, s[44:47], s56 offen offset:512 sc1
    v_add_u32 v75, s57, v72
    buffer_store_dwordx4 v[72:75], v3, s[44:47], s56 offen offset:768 sc1
    s_nop 1
L_b_nonyq:
    s_setprio 1
    v_add_u32 v4, s58, v1
    v_cvt_f32_u32 v108, v4
    v_mul_u32_u24 v4, v4, v2
    v_cvt_f32_u32 v9, v4
    v_mul_f32 v9, 0x3d800000, v9
    s_mul_i32 s48, s3, 67584
    v_fmamk_f32 v101, v108, 0x3c800000, v9
    v_fmamk_f32 v102, v108, 0x3d000000, v9
    v_fmamk_f32 v103, v108, 0x3d400000, v9
    s_add_u32 s48, s48, s24
    v_cos_f32 v93, v101
    v_sin_f32 v97, v101
    v_cos_f32 v94, v102
    v_sin_f32 v98, v102
    v_cos_f32 v95, v103
    v_sin_f32 v99, v103
    s_add_u32 s52, s48, 4325376
    v_cos_f32 v92, v9
    v_sin_f32 v96, v9
    v_fmamk_f32 v100, v108, 0x3e800000, v9
    v_fmamk_f32 v101, v108, 0x3e880000, v9
    v_fmamk_f32 v102, v108, 0x3e900000, v9
    v_fmamk_f32 v103, v108, 0x3e980000, v9
    v_mul_u32_u24 v4, s22, v2
    s_add_u32 s48, s48, 2162688
    v_cvt_f32_u32 v9, v4
    s_add_u32 s49, s48, 16896
    v_bfe_u32 v3, v0, 2, 4
    s_add_u32 s53, s52, 540672
    v_lshlrev_b32 v240, 5, v3
    v_and_b32 v4, 1, v0
    v_lshlrev_b32 v232, 4, v3
    s_add_u32 s50, s48, 33792
    v_lshl_add_u32 v232, v4, 3, v232
    v_bfe_u32 v3, v0, 1, 1
    v_cvt_pk_bf16_f32 v112, v92, -v96
    v_cvt_pk_bf16_f32 v116, v96, v92
    v_cvt_pk_bf16_f32 v113, v93, -v97
    v_cvt_pk_bf16_f32 v117, v97, v93
    v_cvt_pk_bf16_f32 v114, v94, -v98
    v_cvt_pk_bf16_f32 v118, v98, v94
    v_cvt_pk_bf16_f32 v115, v95, -v99
    v_cvt_pk_bf16_f32 v119, v99, v95
    v_and_b32 v235, 7, v0
    s_add_u32 s54, s52, 1081344
    v_lshl_add_u32 v232, v3, 8, v232
    v_cos_f32 v92, v100
    v_sin_f32 v96, v100
    v_cos_f32 v93, v101
    v_sin_f32 v97, v101
    v_cos_f32 v94, v102
    v_sin_f32 v98, v102
    v_cos_f32 v95, v103
    v_sin_f32 v99, v103
    v_lshlrev_b32 v235, 8, v235
    s_add_u32 s51, s48, 50688
    v_lshl_add_u32 v240, v4, 4, v240
    v_and_b32 v3, 7, v1
    v_bfe_u32 v241, v0, 3, 3
    v_add_u32 v235, s22, v235
    s_add_u32 s55, s52, 1622016
    v_lshlrev_b32 v234, 18, v3
    v_lshlrev_b32 v4, 2, v3
    v_mul_f32 v9, 0x3a800000, v9
    v_cvt_f32_u32 v249, s22
    v_mul_u32_u24 v235, v235, v241
    v_bfe_u32 v13, v0, 2, 3
    v_bfe_u32 v14, v0, 5, 1
    s_lshl_b32 s7, s3, 11
    v_lshrrev_b32 v3, 3, v1
    v_cvt_pk_bf16_f32 v120, v92, -v96
    v_cvt_pk_bf16_f32 v124, v96, v92
    v_cvt_pk_bf16_f32 v121, v93, -v97
    v_cvt_pk_bf16_f32 v125, v97, v93
    v_cvt_pk_bf16_f32 v122, v94, -v98
    v_cvt_pk_bf16_f32 v126, v98, v94
    v_cvt_pk_bf16_f32 v123, v95, -v99
    v_cvt_pk_bf16_f32 v127, v99, v95
    v_fmamk_f32 v249, v249, 0x3a000000, v9
    v_cvt_f32_u32 v235, v235
    v_lshl_add_u32 v233, v13, 5, v14
    v_lshl_add_u32 v12, v14, 5, v13
    v_lshl_add_u32 v234, v3, 7, v234
    s_lshl_b32 s9, s22, 10
    v_fmamk_f32 v93, v108, 0x3c000000, v9
    v_fmamk_f32 v95, v108, 0x3c000000, v249
    v_fmamk_f32 v96, v108, 0x3b000000, v9
    v_fmamk_f32 v97, v108, 0x3c200000, v9
    v_fmamk_f32 v98, v108, 0x3b000000, v249
    v_fmamk_f32 v99, v108, 0x3c200000, v249
    v_fmamk_f32 v100, v108, 0x3b800000, v9
    v_fmamk_f32 v101, v108, 0x3c400000, v9
    v_fmamk_f32 v102, v108, 0x3b800000, v249
    v_fmamk_f32 v103, v108, 0x3c400000, v249
    v_fmamk_f32 v104, v108, 0x3bc00000, v9
    v_fmamk_f32 v105, v108, 0x3c600000, v9
    v_fmamk_f32 v106, v108, 0x3bc00000, v249
    v_fmamk_f32 v107, v108, 0x3c600000, v249
    v_mul_f32 v235, 0x3a000000, v235
    v_mul_u32_u24 v233, 8448, v233
    v_mul_u32_u24 v12, 8448, v12
    v_lshlrev_b32 v109, 10, v2
    v_lshrrev_b32 v3, 4, v0
    s_lshl_b32 s62, s22, 4
    v_cos_f32 v128, v9
    v_sin_f32 v144, v9
    v_cos_f32 v129, v93
    v_sin_f32 v145, v93
    v_cos_f32 v130, v249
    v_sin_f32 v146, v249
    v_cos_f32 v131, v95
    v_sin_f32 v147, v95
    v_cos_f32 v132, v96
    v_sin_f32 v148, v96
    v_cos_f32 v133, v97
    v_sin_f32 v149, v97
    v_cos_f32 v134, v98
    v_sin_f32 v150, v98
    v_cos_f32 v135, v99
    v_sin_f32 v151, v99
    v_cos_f32 v136, v100
    v_sin_f32 v152, v100
    v_cos_f32 v137, v101
    v_sin_f32 v153, v101
    v_cos_f32 v138, v102
    v_sin_f32 v154, v102
    v_cos_f32 v139, v103
    v_sin_f32 v155, v103
    v_cos_f32 v140, v104
    v_sin_f32 v156, v104
    v_cos_f32 v141, v105
    v_sin_f32 v157, v105
    v_cos_f32 v142, v106
    v_sin_f32 v158, v106
    v_cos_f32 v143, v107
    v_sin_f32 v159, v107
    v_cos_f32 v16, v235
    v_sin_f32 v17, v235
    v_add_u32 v233, v233, v248
    v_add_u32 v12, v12, v248
    v_lshl_add_u32 v109, v1, 4, v109
    v_add_u32 v240, s7, v240
    v_add_u32 v232, s7, v232
    v_mov_b32 v242, v4
    v_lshl_add_u32 v234, v3, 3, v234
    v_lshlrev_b32 v241, 12, v241
    s_add_u32 s62, s62, 12910592
    buffer_load_dwordx4 v[28:31], v233, s[44:47], s48 offen sc1
    buffer_load_dwordx4 v[32:35], v233, s[44:47], s49 offen sc1
    buffer_load_dwordx4 v[36:39], v233, s[44:47], s50 offen sc1
    buffer_load_dwordx4 v[40:43], v233, s[44:47], s51 offen sc1
    v_and_b32 v3, 7, v1
    v_cvt_f32_u32 v249, v3
    v_mul_u32_u24 v3, v3, v2
    v_cvt_f32_u32 v9, v3
    v_mul_f32 v9, 0x3e800000, v9
    v_lshrrev_b32 v3, 3, v1
    v_fmamk_f32 v249, v249, 0x3e000000, v9
    v_cvt_f32_u32 v108, v3
    v_fmamk_f32 v77, v108, 0x3f000000, v9
    v_fmamk_f32 v79, v108, 0x3f000000, v249
    v_fmamk_f32 v88, v108, 0x3e000000, v9
    v_fmamk_f32 v89, v108, 0x3f200000, v9
    v_fmamk_f32 v90, v108, 0x3e000000, v249
    v_fmamk_f32 v91, v108, 0x3f200000, v249
    v_cos_f32 v68, v9
    v_sin_f32 v72, v9
    v_cos_f32 v69, v77
    v_sin_f32 v73, v77
    v_cos_f32 v70, v249
    v_sin_f32 v74, v249
    v_cos_f32 v71, v79
    v_sin_f32 v75, v79
    v_cos_f32 v80, v88
    v_sin_f32 v84, v88
    v_cos_f32 v81, v89
    v_sin_f32 v85, v89
    v_cos_f32 v82, v90
    v_sin_f32 v86, v90
    v_cos_f32 v83, v91
    v_sin_f32 v87, v91
    v_cvt_pk_bf16_f32 v160, v68, v69
    v_cvt_pk_bf16_f32 v161, v70, v71
    v_cvt_pk_bf16_f32 v162, -v72, -v73
    v_cvt_pk_bf16_f32 v163, -v74, -v75
    v_cvt_pk_bf16_f32 v170, v80, v81
    v_cvt_pk_bf16_f32 v171, v82, v83
    v_cvt_pk_bf16_f32 v172, -v84, -v85
    v_cvt_pk_bf16_f32 v173, -v86, -v87
    v_cvt_pk_bf16_f32 v174, -v80, -v81
    v_cvt_pk_bf16_f32 v175, -v82, -v83
    v_cvt_pk_bf16_f32 v176, v84, v85
    v_cvt_pk_bf16_f32 v177, v86, v87
    v_cvt_pk_bf16_f32 v178, v80, v81
    v_cvt_pk_bf16_f32 v179, v82, v83
    v_fmamk_f32 v76, v108, 0x3e800000, v9
    v_fmamk_f32 v77, v108, 0x3f400000, v9
    v_fmamk_f32 v78, v108, 0x3e800000, v249
    v_fmamk_f32 v79, v108, 0x3f400000, v249
    v_fmamk_f32 v88, v108, 0x3ec00000, v9
    v_fmamk_f32 v89, v108, 0x3f600000, v9
    v_fmamk_f32 v90, v108, 0x3ec00000, v249
    v_fmamk_f32 v91, v108, 0x3f600000, v249
    v_cos_f32 v68, v76
    v_sin_f32 v72, v76
    v_cos_f32 v69, v77
    v_sin_f32 v73, v77
    v_cos_f32 v70, v78
    v_sin_f32 v74, v78
    v_cos_f32 v71, v79
    v_sin_f32 v75, v79
    v_cos_f32 v80, v88
    v_sin_f32 v84, v88
    v_cos_f32 v81, v89
    v_sin_f32 v85, v89
    v_cos_f32 v82, v90
    v_sin_f32 v86, v90
    v_cos_f32 v83, v91
    v_sin_f32 v87, v91
    v_cvt_pk_bf16_f32 v180, v68, v69
    v_cvt_pk_bf16_f32 v181, v70, v71
    v_cvt_pk_bf16_f32 v182, -v72, -v73
    v_cvt_pk_bf16_f32 v183, -v74, -v75
    v_cvt_pk_bf16_f32 v184, -v68, -v69
    v_cvt_pk_bf16_f32 v185, -v70, -v71
    v_cvt_pk_bf16_f32 v186, v72, v73
    v_cvt_pk_bf16_f32 v187, v74, v75
    v_cvt_pk_bf16_f32 v190, v80, v81
    v_cvt_pk_bf16_f32 v191, v82, v83
    v_cvt_pk_bf16_f32 v192, -v84, -v85
    v_cvt_pk_bf16_f32 v193, -v86, -v87
    v_cvt_pk_bf16_f32 v194, -v80, -v81
    v_cvt_pk_bf16_f32 v195, -v82, -v83
    v_cvt_pk_bf16_f32 v196, v84, v85
    v_cvt_pk_bf16_f32 v197, v86, v87
    v_cvt_pk_bf16_f32 v198, v80, v81
    v_cvt_pk_bf16_f32 v199, v82, v83
    v_and_b32 v3, 0x3ff, v234
    v_mul_u32_u24 v4, 264, v242
    v_add_u32 v4, v4, v3
    ds_read_b64 v[52:53], v4 offset:0
    ds_read_b64 v[44:45], v3 offset:54848
    ds_read_b64 v[46:47], v3 offset:55104
    ds_read_b64 v[48:49], v3 offset:55360
    ds_read_b64 v[50:51], v3 offset:55616
    ds_read_b64 v[54:55], v4 offset:256
    ds_read_b64 v[56:57], v4 offset:512
    ds_read_b64 v[58:59], v4 offset:768
    ds_read_b32 v10, v242 offset:53760
    s_waitcnt lgkmcnt(8)
    v_lshlrev_b32 v164, 16, v52
    v_lshlrev_b32 v166, 16, v53
    s_waitcnt lgkmcnt(7)
    v_lshlrev_b32 v165, 16, v44
    v_lshlrev_b32 v167, 16, v45
    s_waitcnt lgkmcnt(6)
    v_lshlrev_b32 v169, 16, v46
    v_lshlrev_b32 v189, 16, v47
    s_waitcnt lgkmcnt(5)
    v_lshlrev_b32 v25, 16, v48
    v_lshlrev_b32 v27, 16, v49
    s_waitcnt lgkmcnt(4)
    v_lshlrev_b32 v245, 16, v50
    v_lshlrev_b32 v247, 16, v51
    s_waitcnt lgkmcnt(3)
    v_lshlrev_b32 v168, 16, v54
    v_lshlrev_b32 v188, 16, v55
    s_waitcnt lgkmcnt(2)
    v_lshlrev_b32 v24, 16, v56
    v_lshlrev_b32 v26, 16, v57
    s_waitcnt lgkmcnt(1)
    v_lshlrev_b32 v244, 16, v58
    v_lshlrev_b32 v246, 16, v59
    v_mul_f32 v164, v164, v165
    v_and_b32 v52, 0xffff0000, v52
    v_and_b32 v44, 0xffff0000, v44
    v_mul_f32 v166, v166, v167
    v_and_b32 v53, 0xffff0000, v53
    v_and_b32 v45, 0xffff0000, v45
    v_mul_f32 v168, v168, v169
    v_and_b32 v54, 0xffff0000, v54
    v_and_b32 v46, 0xffff0000, v46
    v_mul_f32 v188, v188, v189
    v_and_b32 v55, 0xffff0000, v55
    v_and_b32 v47, 0xffff0000, v47
    v_mul_f32 v24, v24, v25
    v_and_b32 v56, 0xffff0000, v56
    v_and_b32 v48, 0xffff0000, v48
    v_mul_f32 v26, v26, v27
    v_and_b32 v57, 0xffff0000, v57
    v_and_b32 v49, 0xffff0000, v49
    v_mul_f32 v244, v244, v245
    v_and_b32 v58, 0xffff0000, v58
    v_and_b32 v50, 0xffff0000, v50
    v_mul_f32 v246, v246, v247
    v_and_b32 v59, 0xffff0000, v59
    v_and_b32 v51, 0xffff0000, v51
    v_mul_f32 v165, v52, v44
    v_mul_f32 v167, v53, v45
    v_mul_f32 v169, v54, v46
    v_mul_f32 v189, v55, v47
    v_mul_f32 v25, v56, v48
    v_mul_f32 v27, v57, v49
    v_mul_f32 v245, v58, v50
    v_mul_f32 v247, v59, v51
    s_waitcnt lgkmcnt(0)
    v_sub_f32 v11, 1.0, v10
    v_mul_f32 v11, 0x3600b7c2, v11
    v_mul_f32 v164, v10, v164
    v_mul_f32 v165, v10, v165
    v_mul_f32 v166, v10, v166
    v_mul_f32 v167, v10, v167
    v_mul_f32 v168, v10, v168
    v_mul_f32 v169, v10, v169
    v_mul_f32 v188, v10, v188
    v_mul_f32 v189, v10, v189
    v_mul_f32 v24, v10, v24
    v_mul_f32 v25, v10, v25
    v_mul_f32 v26, v10, v26
    v_mul_f32 v27, v10, v27
    v_mul_f32 v244, v10, v244
    v_mul_f32 v245, v10, v245
    v_mul_f32 v246, v10, v246
    v_mul_f32 v247, v10, v247
    s_setprio 3
    s_mov_b32 s59, 30000
L_tag4:
    s_waitcnt vmcnt(3)
    v_xor_b32 v28, v236, v28
    v_xor_b32 v29, v237, v29
    v_xor_b32 v30, v238, v30
    v_xor_b32 v31, v239, v31
    v_or3_b32 v6, v28, v29, v30
    v_or_b32 v6, v6, v31
    s_waitcnt vmcnt(2)
    v_xor_b32 v32, v236, v32
    v_xor_b32 v33, v237, v33
    v_xor_b32 v34, v238, v34
    v_xor_b32 v35, v239, v35
    v_or3_b32 v6, v6, v32, v33
    v_or3_b32 v6, v6, v34, v35
    s_waitcnt vmcnt(1)
    v_xor_b32 v36, v236, v36
    v_xor_b32 v37, v237, v37
    v_xor_b32 v38, v238, v38
    v_xor_b32 v39, v239, v39
    v_or3_b32 v6, v6, v36, v37
    v_or3_b32 v6, v6, v38, v39
    s_waitcnt vmcnt(0)
    v_xor_b32 v40, v236, v40
    v_xor_b32 v41, v237, v41
    v_xor_b32 v42, v238, v42
    v_xor_b32 v43, v239, v43
    v_or3_b32 v6, v6, v40, v41
    v_or3_b32 v6, v6, v42, v43
    v_and_b32 v6, 0x10001, v6
    v_cmp_ne_u32 vcc, 0, v6
    s_cbranch_vccz L_tag4_out
    s_sub_u32 s59, s59, 1
    s_cbranch_scc1 L_tag4_out
    s_wqm_b64 exec, vcc
    s_sleep 4
    buffer_load_dwordx4 v[28:31], v233, s[44:47], s48 offen sc1
    buffer_load_dwordx4 v[32:35], v233, s[44:47], s49 offen sc1
    buffer_load_dwordx4 v[36:39], v233, s[44:47], s50 offen sc1
    buffer_load_dwordx4 v[40:43], v233, s[44:47], s51 offen sc1
    s_branch L_tag4
L_tag4_out:
    s_mov_b64 exec, -1
    s_mov_b64 exec, s[10:11]
    ds_write_b128 v240, v[28:31] offset:20992
    ds_write_b128 v240, v[32:35] offset:21504
    ds_write_b128 v240, v[36:39] offset:22016
    ds_write_b128 v240, v[40:43] offset:22528
    s_mov_b64 exec, -1
    s_waitcnt lgkmcnt(0)
    s_barrier
    ds_read_b128 v[28:31], v109 offset:20992
    buffer_load_dwordx4 v[216:219], v12, s[44:47], s52 offen sc1
    buffer_load_dwordx4 v[220:223], v12, s[44:47], s53 offen sc1
    v_and_b32 v3, 7, v1
    ds_read_b128 v[32:35], v109 offset:21248
    s_mul_i32 s26, s3, 2080
    buffer_load_dwordx4 v[224:227], v12, s[44:47], s54 offen sc1
    s_lshl_b32 s24, s3, 19
    ds_read_b128 v[36:39], v109 offset:21504
    buffer_load_dwordx4 v[228:231], v12, s[44:47], s55 offen sc1
    s_add_u32 s24, s24, s9
    buffer_load_dwordx4 v[20:23], v241, s[44:47], s62 offen sc1
    ds_read_b128 v[40:43], v109 offset:21760
    v_add_u32 v242, s26, v5
    s_add_u32 s25, s24, 262144
    ds_read_b128 v[44:47], v109 offset:25088
    ds_read_b128 v[48:51], v109 offset:25344
    ds_read_b128 v[52:55], v109 offset:25600
    ds_read_b128 v[56:59], v109 offset:25856
    v_mul_u32_u24 v109, 1040, v3
    v_and_b32 v3, 0x3ff, v234
    v_add_u32 v109, v109, v3
    s_waitcnt lgkmcnt(6)
    v_swap_b32 v29, v32
    s_waitcnt lgkmcnt(5)
    v_swap_b32 v30, v36
    v_swap_b32 v34, v37
    s_waitcnt lgkmcnt(4)
    v_swap_b32 v31, v40
    v_swap_b32 v35, v41
    s_nop 0
    v_mfma_f32_16x16x32_bf16 v[60:63], v[28:31], v[112:115], 0
    v_swap_b32 v39, v42
    v_mfma_f32_16x16x32_bf16 v[64:67], v[28:31], v[116:119], 0
    s_waitcnt lgkmcnt(2)
    v_swap_b32 v45, v48
    s_waitcnt lgkmcnt(1)
    v_swap_b32 v46, v52
    v_mfma_f32_16x16x32_bf16 v[68:71], v[32:35], v[112:115], 0
    s_waitcnt lgkmcnt(0)
    v_swap_b32 v47, v56
    v_mfma_f32_16x16x32_bf16 v[72:75], v[32:35], v[116:119], 0
    v_swap_b32 v50, v53
    v_mfma_f32_16x16x32_bf16 v[60:63], v[44:47], v[120:123], v[60:63]
    v_swap_b32 v51, v57
    v_mfma_f32_16x16x32_bf16 v[64:67], v[44:47], v[124:127], v[64:67]
    v_swap_b32 v55, v58
    v_mfma_f32_16x16x32_bf16 v[76:79], v[36:39], v[112:115], 0
    s_nop 3
    v_mul_f32 v93, v60, v144
    v_mfma_f32_16x16x32_bf16 v[80:83], v[36:39], v[116:119], 0
    v_mul_f32 v95, v61, v145
    v_mul_f32 v92, v64, v144
    v_mfma_f32_16x16x32_bf16 v[68:71], v[48:51], v[120:123], v[68:71]
    v_mul_f32 v94, v65, v145
    v_mul_f32 v96, v66, v146
    v_mfma_f32_16x16x32_bf16 v[72:75], v[48:51], v[124:127], v[72:75]
    v_mul_f32 v97, v62, v146
    v_mul_f32 v98, v67, v147
    v_mfma_f32_16x16x32_bf16 v[84:87], v[40:43], v[112:115], 0
    v_mul_f32 v99, v63, v147
    v_fma_f32 v60, v60, v128, -v92
    v_mfma_f32_16x16x32_bf16 v[88:91], v[40:43], v[116:119], 0
    v_fma_f32 v64, v64, v128, v93
    v_fma_f32 v61, v61, v129, -v94
    v_mfma_f32_16x16x32_bf16 v[76:79], v[52:55], v[120:123], v[76:79]
    v_fma_f32 v65, v65, v129, v95
    v_fma_f32 v62, v62, v130, -v96
    v_mfma_f32_16x16x32_bf16 v[80:83], v[52:55], v[124:127], v[80:83]
    v_fma_f32 v66, v66, v130, v97
    v_fma_f32 v63, v63, v131, -v98
    v_fma_f32 v67, v67, v131, v99
    v_cvt_pk_bf16_f32 v200, v60, v61
    v_cvt_pk_bf16_f32 v202, v64, v65
    v_cvt_pk_bf16_f32 v201, v62, v63
    v_cvt_pk_bf16_f32 v203, v66, v67
    v_mfma_f32_16x16x32_bf16 v[84:87], v[56:59], v[120:123], v[84:87]
    v_mul_f32 v100, v72, v148
    v_mul_f32 v101, v68, v148
    v_mfma_f32_16x16x32_bf16 v[88:91], v[56:59], v[124:127], v[88:91]
    v_mul_f32 v102, v73, v149
    v_mul_f32 v103, v69, v149
    v_mul_f32 v104, v74, v150
    v_mul_f32 v105, v70, v150
    v_mul_f32 v106, v75, v151
    v_mul_f32 v107, v71, v151
    v_mfma_f32_16x16x32_bf16 v[28:31], v[200:203], v[160:163], 0
    v_fma_f32 v68, v68, v132, -v100
    v_fma_f32 v72, v72, v132, v101
    v_mfma_f32_16x16x32_bf16 v[32:35], v[200:203], v[160:163], 0
    v_fma_f32 v69, v69, v133, -v102
    v_fma_f32 v73, v73, v133, v103
    v_mfma_f32_16x16x32_bf16 v[36:39], v[200:203], v[160:163], 0
    v_fma_f32 v70, v70, v134, -v104
    v_fma_f32 v74, v74, v134, v105
    v_mfma_f32_16x16x32_bf16 v[40:43], v[200:203], v[160:163], 0
    v_fma_f32 v71, v71, v135, -v106
    v_fma_f32 v75, v75, v135, v107
    v_cvt_pk_bf16_f32 v204, v68, v69
    v_cvt_pk_bf16_f32 v206, v72, v73
    v_cvt_pk_bf16_f32 v205, v70, v71
    v_cvt_pk_bf16_f32 v207, v74, v75
    v_mul_f32 v92, v80, v152
    v_mul_f32 v93, v76, v152
    v_mul_f32 v94, v81, v153
    v_mul_f32 v95, v77, v153
    v_mul_f32 v96, v82, v154
    v_mul_f32 v97, v78, v154
    v_mul_f32 v98, v83, v155
    v_mul_f32 v99, v79, v155
    v_mfma_f32_16x16x32_bf16 v[28:31], v[204:207], v[170:173], v[28:31]
    v_fma_f32 v76, v76, v136, -v92
    v_fma_f32 v80, v80, v136, v93
    v_mfma_f32_16x16x32_bf16 v[32:35], v[204:207], v[172:175], v[32:35]
    v_fma_f32 v77, v77, v137, -v94
    v_fma_f32 v81, v81, v137, v95
    v_mfma_f32_16x16x32_bf16 v[36:39], v[204:207], v[174:177], v[36:39]
    v_fma_f32 v78, v78, v138, -v96
    v_fma_f32 v82, v82, v138, v97
    v_mfma_f32_16x16x32_bf16 v[40:43], v[204:207], v[176:179], v[40:43]
    v_fma_f32 v79, v79, v139, -v98
    v_fma_f32 v83, v83, v139, v99
    v_cvt_pk_bf16_f32 v208, v76, v77
    v_cvt_pk_bf16_f32 v210, v80, v81
    v_cvt_pk_bf16_f32 v209, v78, v79
    v_cvt_pk_bf16_f32 v211, v82, v83
    v_mul_f32 v100, v88, v156
    v_mul_f32 v101, v84, v156
    v_mul_f32 v102, v89, v157
    v_mul_f32 v103, v85, v157
    v_mul_f32 v104, v90, v158
    v_mul_f32 v105, v86, v158
    v_mul_f32 v106, v91, v159
    v_mul_f32 v107, v87, v159
    v_mfma_f32_16x16x32_bf16 v[28:31], v[208:211], v[180:183], v[28:31]
    v_fma_f32 v84, v84, v140, -v100
    v_fma_f32 v88, v88, v140, v101
    v_mfma_f32_16x16x32_bf16 v[32:35], v[208:211], v[184:187], v[32:35]
    v_fma_f32 v85, v85, v141, -v102
    v_fma_f32 v89, v89, v141, v103
    v_mfma_f32_16x16x32_bf16 v[36:39], v[208:211], v[180:183], v[36:39]
    v_fma_f32 v86, v86, v142, -v104
    v_fma_f32 v90, v90, v142, v105
    v_mfma_f32_16x16x32_bf16 v[40:43], v[208:211], v[184:187], v[40:43]
    v_fma_f32 v87, v87, v143, -v106
    v_fma_f32 v91, v91, v143, v107
    v_cvt_pk_bf16_f32 v212, v84, v85
    v_cvt_pk_bf16_f32 v214, v88, v89
    v_cvt_pk_bf16_f32 v213, v86, v87
    v_cvt_pk_bf16_f32 v215, v90, v91
    s_nop 1
    v_mfma_f32_16x16x32_bf16 v[28:31], v[212:215], v[190:193], v[28:31]
    v_mfma_f32_16x16x32_bf16 v[32:35], v[212:215], v[196:199], v[32:35]
    v_mfma_f32_16x16x32_bf16 v[36:39], v[212:215], v[194:197], v[36:39]
    v_mfma_f32_16x16x32_bf16 v[40:43], v[212:215], v[192:195], v[40:43]
    s_mov_b32 s59, 30000
L_tag5:
    s_waitcnt vmcnt(4)
    v_xor_b32 v216, v236, v216
    v_xor_b32 v217, v237, v217
    v_xor_b32 v218, v238, v218
    v_xor_b32 v219, v239, v219
    v_or3_b32 v6, v216, v217, v218
    v_or_b32 v6, v6, v219
    s_waitcnt vmcnt(3)
    v_xor_b32 v220, v236, v220
    v_xor_b32 v221, v237, v221
    v_xor_b32 v222, v238, v222
    v_xor_b32 v223, v239, v223
    v_or3_b32 v6, v6, v220, v221
    v_or3_b32 v6, v6, v222, v223
    s_waitcnt vmcnt(2)
    v_xor_b32 v224, v236, v224
    v_xor_b32 v225, v237, v225
    v_xor_b32 v226, v238, v226
    v_xor_b32 v227, v239, v227
    v_or3_b32 v6, v6, v224, v225
    v_or3_b32 v6, v6, v226, v227
    s_waitcnt vmcnt(1)
    v_xor_b32 v228, v236, v228
    v_xor_b32 v229, v237, v229
    v_xor_b32 v230, v238, v230
    v_xor_b32 v231, v239, v231
    v_or3_b32 v6, v6, v228, v229
    v_or3_b32 v6, v6, v230, v231
    v_and_b32 v6, 0x10001, v6
    s_waitcnt vmcnt(0)
    v_add3_u32 v7, v20, v21, v22
    v_sub_u32 v7, v23, v7
    v_xor_b32 v7, s57, v7
    v_or_b32 v6, v6, v7
    v_cmp_ne_u32 vcc, 0, v6
    s_cbranch_vccz L_tag5_out
    s_sub_u32 s59, s59, 1
    s_cbranch_scc1 L_tag5_out
    s_wqm_b64 exec, vcc
    s_sleep 8
    buffer_load_dwordx4 v[216:219], v12, s[44:47], s52 offen sc1
    buffer_load_dwordx4 v[220:223], v12, s[44:47], s53 offen sc1
    buffer_load_dwordx4 v[224:227], v12, s[44:47], s54 offen sc1
    buffer_load_dwordx4 v[228:231], v12, s[44:47], s55 offen sc1
    buffer_load_dwordx4 v[20:23], v241, s[44:47], s62 offen sc1
    s_branch L_tag5
L_tag5_out:
    s_mov_b64 exec, -1
    s_or_b32 s56, s22, s3
    s_cmp_lg_u32 s56, 0
    s_cbranch_scc1 L_b_end
    s_mov_b64 exec, 0xffffffff
    v_mov_b32 v3, s57
    v_lshlrev_b32 v4, 2, v0
    s_mov_b32 s56, 12845056
    buffer_store_dword v3, v4, s[44:47], s56 offen sc1
    s_mov_b64 exec, -1
L_b_end:
    s_mov_b64 exec, s[10:11]
    ds_write_b128 v240, v[216:219] offset:8704
    ds_write_b128 v240, v[220:223] offset:9216
    ds_write_b128 v240, v[224:227] offset:9728
    ds_write_b128 v240, v[228:231] offset:10240
    s_mov_b64 exec, -1
    ds_read_b64_tr_b16 v[44:45], v232 offset:8704
    v_lshlrev_b32 v21, 16, v20
    ds_read_b64_tr_b16 v[46:47], v232 offset:9216
    v_and_b32 v20, 0xffff0000, v20
    ds_read_b64_tr_b16 v[48:49], v232 offset:9728
    v_mul_f32 v21, v21, v16
    ds_read_b64_tr_b16 v[50:51], v232 offset:10240
    v_fma_f32 v20, -v20, v17, v21
    v_fma_f32 v28, v11, v28, v164
    v_fma_f32 v29, v11, v29, v165
    v_add_f32_dpp v20, v20, v20 row_ror:8 row_mask:0xf bank_mask:0xf
    v_mov_b32 v21, v20
    v_fma_f32 v30, v11, v30, v166
    v_fma_f32 v31, v11, v31, v167
    v_permlane16_swap_b32 v20, v21
    v_add_f32 v20, v20, v21
    v_mov_b32 v21, v20
    v_fma_f32 v32, v11, v32, v168
    v_fma_f32 v33, v11, v33, v169
    v_permlane32_swap_b32 v20, v21
    v_add_f32 v20, v20, v21
    v_mul_f32 v20, v20, v11
    v_add_f32 v28, v28, v20
    v_sub_f32 v29, v29, v20
    v_add_f32 v30, v30, v20
    v_sub_f32 v31, v31, v20
    v_fma_f32 v34, v11, v34, v188
    v_fma_f32 v35, v11, v35, v189
    v_add_f32 v32, v32, v20
    v_sub_f32 v33, v33, v20
    s_waitcnt lgkmcnt(3)
    v_lshlrev_b32 v60, 16, v44
    v_and_b32 v61, 0xffff0000, v44
    v_lshlrev_b32 v62, 16, v45
    v_and_b32 v63, 0xffff0000, v45
    v_add_f32 v34, v34, v20
    v_sub_f32 v35, v35, v20
    v_fma_f32 v36, v11, v36, v24
    v_fma_f32 v37, v11, v37, v25
    v_fma_f32 v38, v11, v38, v26
    v_fma_f32 v39, v11, v39, v27
    v_fmac_f32 v28, v60, v10
    v_fmac_f32 v29, v61, v10
    v_fmac_f32 v30, v62, v10
    v_fmac_f32 v31, v63, v10
    s_waitcnt lgkmcnt(2)
    v_lshlrev_b32 v64, 16, v46
    v_and_b32 v65, 0xffff0000, v46
    v_lshlrev_b32 v66, 16, v47
    v_and_b32 v67, 0xffff0000, v47
    v_add_f32 v36, v36, v20
    v_sub_f32 v37, v37, v20
    v_add_f32 v38, v38, v20
    v_sub_f32 v39, v39, v20
    v_fma_f32 v40, v11, v40, v244
    v_fma_f32 v41, v11, v41, v245
    v_fma_f32 v42, v11, v42, v246
    v_fma_f32 v43, v11, v43, v247
    v_cvt_pk_bf16_f32 v200, v28, v29
    v_cvt_pk_bf16_f32 v201, v30, v31
    v_fmac_f32 v32, v64, v10
    v_fmac_f32 v33, v65, v10
    v_fmac_f32 v34, v66, v10
    v_fmac_f32 v35, v67, v10
    s_waitcnt lgkmcnt(1)
    v_lshlrev_b32 v68, 16, v48
    v_and_b32 v69, 0xffff0000, v48
    v_lshlrev_b32 v70, 16, v49
    v_and_b32 v71, 0xffff0000, v49
    v_add_f32 v40, v40, v20
    v_sub_f32 v41, v41, v20
    v_add_f32 v42, v42, v20
    v_sub_f32 v43, v43, v20
    ds_write_b64 v109, v[200:201] offset:0
    v_cvt_pk_bf16_f32 v202, v32, v33
    v_cvt_pk_bf16_f32 v203, v34, v35
    v_fmac_f32 v36, v68, v10
    v_fmac_f32 v37, v69, v10
    v_fmac_f32 v38, v70, v10
    v_fmac_f32 v39, v71, v10
    s_waitcnt lgkmcnt(1)
    v_lshlrev_b32 v72, 16, v50
    v_and_b32 v73, 0xffff0000, v50
    v_lshlrev_b32 v74, 16, v51
    v_and_b32 v75, 0xffff0000, v51
    ds_write_b64 v109, v[202:203] offset:256
    v_cvt_pk_bf16_f32 v204, v36, v37
    v_cvt_pk_bf16_f32 v205, v38, v39
    v_fmac_f32 v40, v72, v10
    v_fmac_f32 v41, v73, v10
    v_fmac_f32 v42, v74, v10
    v_fmac_f32 v43, v75, v10
    ds_write_b64 v109, v[204:205] offset:512
    v_cvt_pk_bf16_f32 v206, v40, v41
    v_cvt_pk_bf16_f32 v207, v42, v43
    ds_write_b64 v109, v[206:207] offset:768
    s_waitcnt lgkmcnt(0)
    s_barrier
    ds_read_b128 v[28:31], v242 offset:0
    ds_read_b128 v[32:35], v242 offset:1040
    s_waitcnt lgkmcnt(1)
    buffer_store_dwordx4 v[28:31], v5, s[12:15], s24 offen sc1
    s_waitcnt lgkmcnt(0)
    buffer_store_dwordx4 v[32:35], v5, s[12:15], s25 offen sc1
    s_endpgm
L_code_end:
.section .rodata,"a"
.p2align 6
.amdhsa_kernel gated_mix__ssm_conv_s4d__spectral_gfnet__prompt_kernel
  .amdhsa_next_free_vgpr 256
  .amdhsa_next_free_sgpr 64
  .amdhsa_accum_offset 256
  .amdhsa_group_segment_fixed_size 0
  .amdhsa_kernarg_size 112
  .amdhsa_user_sgpr_count 2
  .amdhsa_user_sgpr_kernarg_segment_ptr 1
  .amdhsa_system_sgpr_workgroup_id_x 1
.end_amdhsa_kernel
```
